```python
import torch

def _softmax(x, axis=-1):
    return torch.softmax(x, dim=axis)
def _gelu(x):
    return torch.nn.functional.gelu(x, approximate="tanh")
def _silu(x):
    return torch.nn.functional.silu(x)
def _sigmoid(x):
    return torch.sigmoid(x)
def _layernorm(x, axis=-1, eps=1e-5):
    m = x.mean(dim=axis, keepdim=True)
    v = x.var(dim=axis, keepdim=True, unbiased=False)
    return (x - m) / torch.sqrt(v + eps)
def _scatter_add(tgt, idx, src, axis=0):
    return tgt.clone().index_add_(axis, idx, src)
def _segment_sum(src, seg, n):
    out = torch.zeros((n,) + src.shape[1:], dtype=src.dtype)
    return out.index_add_(0, seg, src)
def _pad(x, pw):
    flat = tuple(v for pair in reversed(pw) for v in pair)
    return torch.nn.functional.pad(x, flat)

kernel_name = 'gated_mix__spectral_gfnet__dense_activation_silu__prompt'

def setup_inputs():

    _w = (lambda a: (lambda t: t.to(torch.bfloat16) if t.is_floating_point() else t)(torch.as_tensor(a)))
    def _A_setup():
        B, S, D = 1, 2048, 512
        Df = D // 2 + 1
        return {
            "x": _w((lambda *s: torch.randn(*s, dtype=torch.bfloat16) * 0.05)(B, S, D)),
            "w_r": _w((lambda *s: torch.randn(*s, dtype=torch.bfloat16) * 0.4)(S, Df) * 0.02),
            "w_i": _w((lambda *s: torch.randn(*s, dtype=torch.bfloat16) * 0.4)(S, Df) * 0.02),
        }
    _A_in = _A_setup()

    def _B_setup():
        B, S, D, F = 1, 2048, 512, 1792
        return {
            "x": _w((lambda *s: torch.randn(*s, dtype=torch.bfloat16) * 0.05)(B, S, D)),
            "w1": _w((lambda *s: torch.randn(*s, dtype=torch.bfloat16) * 3.2)(D, F) * (D ** -0.5)),
            "w2": _w((lambda *s: torch.randn(*s, dtype=torch.bfloat16) * 0.05)(F, D) * (F ** -0.5)),
        }
    _B_in = _B_setup()

    return {
        "A_x": _A_in["x"],
        "A_w_r": _A_in["w_r"],
        "A_w_i": _A_in["w_i"],
        "B_x": _B_in["x"],
        "B_w1": _B_in["w1"],
        "B_w2": _B_in["w2"],
        "gate_w": _w((lambda *s: torch.randn(*s, dtype=torch.bfloat16) * 0.05)(512) * 16.0),
    }

def reference(A_x, A_w_r, A_w_i, B_x, B_w1, B_w2, gate_w):
    def _A_ref(x, w_r, w_i):
        B, S, D = x.shape
        X = (lambda x, axes=(-2,-1): torch.fft.rfft2(x.float(), dim=axes))(x, axes=(-2, -1))
        W = w_r + 1j * w_i
        X = X * W
        y = (lambda x, s, axes=(-2,-1): torch.fft.irfft2(x, s=s, dim=axes).to(torch.bfloat16))(X, (S, D), axes=(-2, -1))
        return y

    def _B_ref(x, w1, w2):
        h = torch.einsum("bsd,df->bsf", x, w1)
        h = _silu(h)
        out = torch.einsum("bsf,fd->bsd", h, w2)
        return out

    x = A_x
    g = _sigmoid((x * gate_w).sum(-1, keepdims=True))
    a = _A_ref(x, A_w_r, A_w_i)
    b = _B_ref(x, B_w1, B_w2)
    return g * a + (1 - g) * b
```

```asm
; @launch grid=(256,1,1) block=(512,1,1) lds=163840
.amdgcn_target "amdgcn-amd-amdhsa--gfx950"
.text
.globl gated_mix__spectral_gfnet__dense_activation_silu__prompt_kernel
.p2align 8
.type gated_mix__spectral_gfnet__dense_activation_silu__prompt_kernel,@function
gated_mix__spectral_gfnet__dense_activation_silu__prompt_kernel:
    s_load_dwordx2 s[8:9], s[0:1], 0
    s_load_dwordx2 s[40:41], s[0:1], 72
    s_getpc_b64 s[4:5]
Lpc:
    s_and_b32 s6, s2, 0x38
    s_lshl_b32 s6, s6, 9
    v_and_b32 v5, 0x1f8, v0
    v_lshl_add_u32 v5, v5, 3, s6
    v_min_u32 v5, Lexit-Lpc, v5
    global_load_dword v255, v5, s[4:5]
    v_lshrrev_b32 v4, 6, v0
    v_and_b32 v1, 63, v0
    s_cmp_ge_u32 s2, 256
    v_readfirstlane_b32 s3, v4
    s_cbranch_scc1 Lexit
    s_lshr_b32 s5, s2, 3
    s_and_b32 s6, s2, 1
    s_mul_i32 s6, s6, 28
    s_add_u32 s6, s6, s5
    s_lshr_b32 s46, s6, 3
    s_and_b32 s6, s6, 7
    s_and_b32 s7, s2, 6
    s_lshl2_add_u32 s47, s7, s6
    v_and_b32 v2, 15, v1
    s_and_b32 s4, s2, 7
    s_and_b32 s6, s5, 3
    s_lshl2_add_u32 s6, s4, s6
    v_lshrrev_b32 v3, 4, v1
    s_cmp_ge_u32 s5, 28
    s_cselect_b32 s46, 7, s46
    s_cselect_b32 s47, s6, s47
    v_lshlrev_b32 v30, 4, v1
    s_and_b32 s45, s3, 3
    s_cmp_lt_u32 s3, 4
    s_cbranch_scc1 LF
    s_load_dwordx2 s[20:21], s[0:1], 32
    s_load_dwordx2 s[24:25], s[0:1], 40
    s_and_b32 s6, s3, 2
    s_lshl2_add_u32 s6, s6, 8
    s_load_dwordx2 s[100:101], s[0:1], s6
    s_and_b32 s6, s3, 1
    s_lshl1_add_u32 s6, s5, s6
    s_lshl_b32 s6, s6, 5
    s_add_u32 s6, s6, s4
    s_mul_i32 s6, s6, 514
    s_and_b32 s6, s6, -4
    v_min_u32 v5, 8, v2
    v_lshl_add_u32 v5, v5, 6, s6
    v_mul_u32_u24 v6, 4112, v3
    v_add_u32 v254, v5, v6
    s_setprio 2
    s_bfe_u32 s6, s47, 0x10002
    s_lshl1_add_u32 s6, s47, s6
    s_cmp_eq_u32 s46, 3
    s_cselect_b32 s6, s6, s47
    s_and_b32 s58, s6, 7
    v_lshrrev_b32 v5, 3, v1
    v_and_b32 v6, 7, v1
    v_xor_b32 v7, v6, v3
    v_lshlrev_b32 v7, 4, v7
    s_lshl2_add_u32 s4, s47, s45
    s_lshl_b32 s4, s4, 11
    v_lshl_add_u32 v7, v5, 18, v7
    v_add_u32 v196, s4, v7
    v_xor_b32 v197, 64, v196
    s_lshl_b32 s94, s45, 11
    v_and_b32 v7, 1, v3
    v_lshlrev_b32 v7, 2, v7
    v_xor_b32 v6, v6, v7
    v_lshlrev_b32 v6, 4, v6
    s_lshl2_add_u32 s4, s46, s45
    s_lshl_b32 s4, s4, 7
    s_movk_i32 s5, 3584
    v_mad_u32_u24 v7, v5, s5, v6
    v_add_u32 v192, s4, v7
    v_add_u32 v193, 27648, v192
    s_mul_i32 s93, s45, 10240
    s_add_u32 s93, s93, 98304
    s_mov_b32 s10, 0x200000
    s_mov_b32 s11, 0x20000
    s_mov_b32 s22, 0x1c0000
    s_mov_b32 s23, 0x20000
    s_and_b32 s4, s58, 4
    s_bfe_u32 s5, s2, 0x20001
    s_add_u32 s4, s4, s5
    s_lshl_b32 s36, s4, 7
    s_mul_i32 s12, s36, 1792
    s_and_b32 s4, s46, 3
    s_lshl_b32 s98, s4, 14
    s_lshl_b32 s4, s4, 8
    s_add_u32 s99, s4, s36
    s_waitcnt lgkmcnt(0)
    s_barrier
    s_cmp_eq_u32 s46, 7
    s_cbranch_scc1 Lbhi
    s_and_b32 s4, s98, 0xe000
    s_add_u32 m0, s94, s4
    s_and_b32 s4, s99, 0x380
    buffer_load_dwordx4 v196, s[8:11], s4 offen lds
    buffer_load_dwordx4 v197, s[8:11], s4 offen offset:1024 lds
    s_add_u32 s98, s98, 8192
    s_add_u32 s99, s99, 128
    s_and_b32 s4, s98, 0xe000
    s_add_u32 m0, s94, s4
    s_and_b32 s4, s99, 0x380
    buffer_load_dwordx4 v196, s[8:11], s4 offen lds
    buffer_load_dwordx4 v197, s[8:11], s4 offen offset:1024 lds
    s_add_u32 s98, s98, 8192
    s_add_u32 s99, s99, 128
    s_and_b32 s4, s98, 0xe000
    s_add_u32 m0, s94, s4
    s_and_b32 s4, s99, 0x380
    buffer_load_dwordx4 v196, s[8:11], s4 offen lds
    buffer_load_dwordx4 v197, s[8:11], s4 offen offset:1024 lds
    global_load_dword v254, v254, s[100:101]
    s_add_u32 s98, s98, 8192
    s_add_u32 s99, s99, 128
    s_and_b32 s4, s98, 0xe000
    s_add_u32 m0, s94, s4
    s_and_b32 s4, s99, 0x380
    buffer_load_dwordx4 v196, s[8:11], s4 offen lds
    buffer_load_dwordx4 v197, s[8:11], s4 offen offset:1024 lds
    s_add_u32 s98, s98, 8192
    s_add_u32 s99, s99, 128
    s_and_b32 s4, s98, 0xe000
    s_add_u32 m0, s94, s4
    s_and_b32 s4, s99, 0x380
    buffer_load_dwordx4 v196, s[8:11], s4 offen lds
    buffer_load_dwordx4 v197, s[8:11], s4 offen offset:1024 lds
    s_add_u32 s98, s98, 8192
    s_add_u32 s99, s99, 128
    s_and_b32 s4, s98, 0xe000
    s_add_u32 m0, s94, s4
    s_and_b32 s4, s99, 0x380
    buffer_load_dwordx4 v196, s[8:11], s4 offen lds
    buffer_load_dwordx4 v197, s[8:11], s4 offen offset:1024 lds
    s_add_u32 s98, s98, 8192
    s_add_u32 s99, s99, 128
    s_and_b32 s4, s98, 0xe000
    s_add_u32 m0, s94, s4
    s_and_b32 s4, s99, 0x380
    buffer_load_dwordx4 v196, s[8:11], s4 offen lds
    buffer_load_dwordx4 v197, s[8:11], s4 offen offset:1024 lds
    s_add_u32 s98, s98, 8192
    s_add_u32 s99, s99, 128
    s_and_b32 s4, s98, 0xe000
    s_add_u32 m0, s94, s4
    s_and_b32 s4, s99, 0x380
    buffer_load_dwordx4 v196, s[8:11], s4 offen lds
    buffer_load_dwordx4 v197, s[8:11], s4 offen offset:1024 lds
    s_add_u32 m0, s93, 0
    s_nop 0
    buffer_load_dwordx4 v192, s[20:23], s12 offen lds
    buffer_load_dwordx4 v193, s[20:23], s12 offen offset:1024 lds
    s_add_u32 m0, s93, 2048
    s_add_u32 s7, s12, 57344
    buffer_load_dwordx4 v192, s[20:23], s7 offen lds
    buffer_load_dwordx4 v193, s[20:23], s7 offen offset:1024 lds
    s_add_u32 m0, s93, 4096
    s_add_u32 s7, s12, 114688
    buffer_load_dwordx4 v192, s[20:23], s7 offen lds
    buffer_load_dwordx4 v193, s[20:23], s7 offen offset:1024 lds
    s_add_u32 m0, s93, 6144
    s_add_u32 s7, s12, 172032
    buffer_load_dwordx4 v192, s[20:23], s7 offen lds
    buffer_load_dwordx4 v193, s[20:23], s7 offen offset:1024 lds
    s_branch Lg2
LF:
    s_setprio 3
    s_load_dwordx2 s[28:29], s[0:1], 48
    s_load_dwordx2 s[36:37], s[0:1], 64
    s_memrealtime s[54:55]
    s_lshl3_add_u32 s44, s47, s46
    v_lshlrev_b32 v156, 8, v3
    v_lshl_add_u32 v156, v2, 2, v156
    s_lshl_b32 s4, s45, 9
    s_add_u32 s4, s4, s44
    s_lshl_b32 s4, s4, 10
    s_add_u32 s5, s4, 0x40000
    s_mov_b32 s10, 0x200000
    s_mov_b32 s11, 0x20000
    s_mov_b32 s30, 0x400
    s_mov_b32 s31, 0x20000
    v_mov_b32 v29, 0
    v_mov_b32 v31, 0x20000
    v_lshrrev_b32 v4, 4, v0
    v_and_b32 v4, 28, v4
    v_add_u32 v26, 163072, v4
    v_and_b32 v4, 3, v1
    v_lshlrev_b32 v4, 2, v4
    v_add_u32 v27, 163072, v4
    v_lshl_add_u32 v5, v1, 2, v31
    s_cmp_eq_u32 s3, 0
    s_cselect_b64 exec, 0xffff, 0
    ds_write_b32 v5, v29 offset:32000
    s_mov_b64 exec, -1
    v_lshlrev_b32 v4, 2, v3
    v_add_u32 v5, 0, v4
    v_mul_u32_u24 v92, v5, v2
    v_add_u32 v5, 1, v4
    v_mul_u32_u24 v93, v5, v2
    v_add_u32 v5, 2, v4
    v_mul_u32_u24 v94, v5, v2
    v_add_u32 v5, 3, v4
    v_mul_u32_u24 v95, v5, v2
    v_and_b32 v96, 15, v92
    v_and_b32 v97, 15, v93
    v_and_b32 v98, 15, v94
    v_and_b32 v99, 15, v95
    v_cvt_f32_u32 v96, v96
    v_cvt_f32_u32 v97, v97
    v_cvt_f32_u32 v98, v98
    v_cvt_f32_u32 v99, v99
    v_mul_f32 v96, 0x3d800000, v96
    v_mul_f32 v97, 0x3d800000, v97
    v_mul_f32 v98, 0x3d800000, v98
    v_mul_f32 v99, 0x3d800000, v99
    v_cos_f32 v100, v96
    v_cos_f32 v101, v97
    v_cos_f32 v102, v98
    v_cos_f32 v103, v99
    v_sin_f32 v104, v96
    v_sin_f32 v105, v97
    v_sin_f32 v106, v98
    v_sin_f32 v107, v99
    v_cvt_pk_bf16_f32 v8, v100, v104
    v_cvt_pk_bf16_f32 v12, -v104, v100
    v_cvt_pk_bf16_f32 v9, v101, v105
    v_cvt_pk_bf16_f32 v13, -v105, v101
    v_cvt_pk_bf16_f32 v10, v102, v106
    v_cvt_pk_bf16_f32 v14, -v106, v102
    v_cvt_pk_bf16_f32 v11, v103, v107
    v_cvt_pk_bf16_f32 v15, -v107, v103
    v_cvt_f32_u32 v92, v92
    v_cvt_f32_u32 v93, v93
    v_cvt_f32_u32 v94, v94
    v_cvt_f32_u32 v95, v95
    v_mul_f32 v92, 0x3b800000, v92
    v_mul_f32 v93, 0x3b800000, v93
    v_mul_f32 v94, 0x3b800000, v94
    v_mul_f32 v95, 0x3b800000, v95
    v_cos_f32 v16, v92
    v_cos_f32 v17, v93
    v_cos_f32 v18, v94
    v_cos_f32 v19, v95
    v_sin_f32 v20, v92
    v_sin_f32 v21, v93
    v_sin_f32 v22, v94
    v_sin_f32 v23, v95
    s_waitcnt lgkmcnt(0)
    buffer_load_dword v48, v156, s[8:11], s4 offen offset:0
    buffer_load_dword v49, v156, s[8:11], s4 offen offset:64
    buffer_load_dword v50, v156, s[8:11], s4 offen offset:128
    buffer_load_dword v51, v156, s[8:11], s4 offen offset:192
    buffer_load_dword v52, v156, s[8:11], s5 offen offset:0
    buffer_load_dword v53, v156, s[8:11], s5 offen offset:64
    buffer_load_dword v54, v156, s[8:11], s5 offen offset:128
    buffer_load_dword v55, v156, s[8:11], s5 offen offset:192
    s_barrier
    buffer_load_dword v56, v156, s[28:31], 0 offen offset:0
    buffer_load_dword v57, v156, s[28:31], 0 offen offset:64
    buffer_load_dword v58, v156, s[28:31], 0 offen offset:128
    buffer_load_dword v59, v156, s[28:31], 0 offen offset:192
    s_load_dwordx2 s[12:13], s[0:1], 8
    s_load_dwordx2 s[16:17], s[0:1], 16
    s_mov_b32 s38, 0x100
    s_mov_b32 s39, 0x20000
    s_mov_b32 s42, 0x10000000
    s_mov_b32 s43, 0x20000
    s_or_b32 s54, s54, 1
    v_mov_b32 v6, s54
    v_mov_b32 v7, s55
    s_or_b32 s6, s2, s3
    s_cmp_eq_u32 s6, 0
    s_cselect_b64 exec, 1, 0
    buffer_store_dwordx2 v[6:7], v29, s[36:39], 0 offen sc1
    s_mov_b64 exec, -1
    s_cmp_eq_u32 s3, 0
    s_cselect_b32 s50, 0x00010001, 0
    s_mov_b32 s51, s50
    v_lshrrev_b32 v4, 1, v2
    v_and_b32 v5, 1, v2
    v_lshlrev_b32 v5, 9, v5
    v_lshlrev_b32 v6, 9, v3
    v_add_u32 v6, s44, v6
    v_mad_u32_u24 v92, v6, v4, v5
    v_and_b32 v92, 0x7ff, v92
    v_add_u32 v6, 256, v6
    v_mad_u32_u24 v93, v6, v4, v5
    v_and_b32 v93, 0x7ff, v93
    s_lshl_b32 s6, s45, 6
    v_lshl_add_u32 v7, v2, 2, s6
    v_add_u32 v96, 0, v7
    v_add_u32 v97, 1, v7
    v_add_u32 v98, 2, v7
    v_add_u32 v99, 3, v7
    v_cvt_f32_u32 v92, v92
    v_cvt_f32_u32 v93, v93
    v_cvt_f32_u32 v96, v96
    v_cvt_f32_u32 v97, v97
    v_cvt_f32_u32 v98, v98
    v_cvt_f32_u32 v99, v99
    v_mul_f32 v92, 0x3a000000, v92
    v_mul_f32 v93, 0x3a000000, v93
    v_mul_f32 v96, 0x3b000000, v96
    v_mul_f32 v97, 0x3b000000, v97
    v_mul_f32 v98, 0x3b000000, v98
    v_mul_f32 v99, 0x3b000000, v99
    v_cos_f32 v100, v92
    v_cos_f32 v101, v93
    v_cos_f32 v32, v96
    v_cos_f32 v34, v97
    v_cos_f32 v36, v98
    v_cos_f32 v38, v99
    v_sin_f32 v104, v92
    v_sin_f32 v105, v93
    v_sin_f32 v33, v96
    v_sin_f32 v35, v97
    v_sin_f32 v37, v98
    v_sin_f32 v39, v99
    v_cvt_pk_bf16_f32 v40, v100, v104
    v_cvt_pk_bf16_f32 v42, v100, -v104
    v_cvt_pk_bf16_f32 v44, -v104, v100
    v_cvt_pk_bf16_f32 v46, v104, v100
    v_cvt_pk_bf16_f32 v41, v101, v105
    v_cvt_pk_bf16_f32 v43, v101, -v105
    v_cvt_pk_bf16_f32 v45, -v105, v101
    v_cvt_pk_bf16_f32 v47, v105, v101
    v_lshl_add_u32 v4, v3, 6, v2
    v_lshlrev_b32 v4, 3, v4
    s_mul_i32 s7, s45, 2064
    s_add_u32 s7, s7, 81920
    v_add_u32 v157, s7, v4
    s_movk_i32 s7, 2064
    v_mul_lo_u32 v4, v3, s7
    v_add_u32 v4, 81920, v4
    v_lshl_add_u32 v158, v7, 3, v4
    v_sub_u32 v5, 253, v7
    v_lshl_add_u32 v159, v5, 3, v4
    v_sub_u32 v5, 256, v7
    v_and_b32 v5, 255, v5
    v_lshl_add_u32 v160, v5, 3, v4
    v_lshlrev_b32 v162, 11, v3
    v_lshl_add_u32 v161, v7, 2, v162
    s_and_b32 s6, s44, 15
    s_lshr_b32 s7, s44, 6
    s_lshl_b32 s7, s7, 4
    s_add_u32 s6, s6, s7
    s_lshl_b32 s6, s6, 4
    s_bfe_u32 s7, s44, 0x20004
    s_lshl_b32 s7, s7, 2
    s_add_u32 s96, s6, s7
    s_waitcnt vmcnt(9)
    v_mfma_f32_16x16x32_bf16 v[60:63], v[48:51], v[8:11], 0
    v_mfma_f32_16x16x32_bf16 v[64:67], v[48:51], v[12:15], 0
    s_waitcnt vmcnt(5)
    v_mfma_f32_16x16x32_bf16 v[68:71], v[52:55], v[8:11], 0
    v_mfma_f32_16x16x32_bf16 v[72:75], v[52:55], v[12:15], 0
    s_nop 4
    v_pk_mul_f32 v[92:93], v[64:65], v[20:21]
    v_pk_mul_f32 v[96:97], v[60:61], v[20:21]
    v_pk_mul_f32 v[94:95], v[66:67], v[22:23]
    v_pk_mul_f32 v[98:99], v[62:63], v[22:23]
    v_pk_fma_f32 v[92:93], v[60:61], v[16:17], v[92:93]
    v_pk_fma_f32 v[96:97], v[64:65], v[16:17], v[96:97] neg_lo:[0,0,1] neg_hi:[0,0,1]
    v_pk_fma_f32 v[94:95], v[62:63], v[18:19], v[94:95]
    v_pk_fma_f32 v[98:99], v[66:67], v[18:19], v[98:99] neg_lo:[0,0,1] neg_hi:[0,0,1]
    v_cvt_pk_bf16_f32 v124, v92, v96
    v_cvt_pk_bf16_f32 v125, v93, v97
    v_cvt_pk_bf16_f32 v126, v94, v98
    v_cvt_pk_bf16_f32 v127, v95, v99
    v_pk_mul_f32 v[100:101], v[72:73], v[20:21]
    v_pk_mul_f32 v[104:105], v[68:69], v[20:21]
    v_pk_mul_f32 v[102:103], v[74:75], v[22:23]
    v_pk_mul_f32 v[106:107], v[70:71], v[22:23]
    v_pk_fma_f32 v[100:101], v[68:69], v[16:17], v[100:101]
    v_pk_fma_f32 v[104:105], v[72:73], v[16:17], v[104:105] neg_lo:[0,0,1] neg_hi:[0,0,1]
    v_pk_fma_f32 v[102:103], v[70:71], v[18:19], v[102:103]
    v_pk_fma_f32 v[106:107], v[74:75], v[18:19], v[106:107] neg_lo:[0,0,1] neg_hi:[0,0,1]
    v_cvt_pk_bf16_f32 v128, v100, v104
    v_cvt_pk_bf16_f32 v129, v101, v105
    v_cvt_pk_bf16_f32 v130, v102, v106
    v_cvt_pk_bf16_f32 v131, v103, v107
    v_mfma_f32_16x16x32_bf16 v[76:79], v[8:11], v[124:127], 0
    v_mfma_f32_16x16x32_bf16 v[80:83], v[12:15], v[124:127], 0
    v_mfma_f32_16x16x32_bf16 v[84:87], v[8:11], v[128:131], 0
    v_mfma_f32_16x16x32_bf16 v[88:91], v[12:15], v[128:131], 0
    s_nop 5
    v_cvt_pk_bf16_f32 v92, v76, v80
    s_nop 0
    v_cvt_pk_bf16_f32 v93, v84, v88
    ds_write_b64 v157, v[92:93] offset:0
    v_cvt_pk_bf16_f32 v94, v77, v81
    v_cvt_pk_bf16_f32 v95, v85, v89
    ds_write_b64 v157, v[94:95] offset:128
    v_cvt_pk_bf16_f32 v96, v78, v82
    v_cvt_pk_bf16_f32 v97, v86, v90
    ds_write_b64 v157, v[96:97] offset:256
    v_cvt_pk_bf16_f32 v98, v79, v83
    v_cvt_pk_bf16_f32 v99, v87, v91
    ds_write_b64 v157, v[98:99] offset:384
    v_mov_b32 v28, 1
    s_mov_b64 exec, 1
    ds_write_b32 v26, v28
    s_mov_b64 exec, -1
    s_mov_b32 s92, 0x1000000
L1:
    ds_read_b32 v28, v27 offset:0
    ds_read_b64 v[124:125], v158 offset:0
    ds_read_b64 v[126:127], v160 offset:0
    ds_read_b64 v[128:129], v158 offset:8
    ds_read_b64 v[130:131], v159 offset:16
    ds_read_b64 v[132:133], v158 offset:16
    ds_read_b64 v[134:135], v159 offset:8
    ds_read_b64 v[136:137], v158 offset:24
    ds_read_b64 v[138:139], v159 offset:0
    s_sub_u32 s92, s92, 1
    s_cbranch_scc1 L2
    s_waitcnt lgkmcnt(0)
    v_cmp_gt_u32 vcc, 1, v28
    s_cbranch_vccnz L1
L2:
    v_mfma_f32_16x16x32_bf16 v[60:63], v[40:43], v[124:127], 0
    v_mfma_f32_16x16x32_bf16 v[64:67], v[44:47], v[124:127], 0
    v_mfma_f32_16x16x32_bf16 v[68:71], v[40:43], v[128:131], 0
    v_mfma_f32_16x16x32_bf16 v[72:75], v[44:47], v[128:131], 0
    v_mfma_f32_16x16x32_bf16 v[76:79], v[40:43], v[132:135], 0
    v_mfma_f32_16x16x32_bf16 v[80:83], v[44:47], v[132:135], 0
    v_mfma_f32_16x16x32_bf16 v[84:87], v[40:43], v[136:139], 0
    v_mfma_f32_16x16x32_bf16 v[88:91], v[44:47], v[136:139], 0
    s_nop 1
    v_pk_add_f32 v[116:117], v[60:61], v[64:65] neg_lo:[0,1] neg_hi:[0,1]
    v_pk_add_f32 v[118:119], v[62:63], v[66:67] neg_lo:[0,1] neg_hi:[0,1]
    v_fmac_f32 v60, v64, v32
    v_fmac_f32 v61, v65, v32
    v_fmac_f32 v62, v66, v32
    v_fmac_f32 v63, v67, v32
    v_fmac_f32 v60, v65, v33
    v_fma_f32 v61, -v64, v33, v61
    v_fmac_f32 v62, v67, v33
    v_fma_f32 v63, -v66, v33, v63
    v_cvt_pk_bf16_f32 v140, v60, v61
    v_cvt_pk_bf16_f32 v144, v62, v63
    v_fmac_f32 v68, v72, v34
    v_fmac_f32 v69, v73, v34
    v_fmac_f32 v70, v74, v34
    v_fmac_f32 v71, v75, v34
    v_fmac_f32 v68, v73, v35
    v_fma_f32 v69, -v72, v35, v69
    v_fmac_f32 v70, v75, v35
    v_fma_f32 v71, -v74, v35, v71
    v_cvt_pk_bf16_f32 v141, v68, v69
    v_cvt_pk_bf16_f32 v145, v70, v71
    v_fmac_f32 v76, v80, v36
    v_fmac_f32 v77, v81, v36
    v_fmac_f32 v78, v82, v36
    v_fmac_f32 v79, v83, v36
    v_fmac_f32 v76, v81, v37
    v_fma_f32 v77, -v80, v37, v77
    v_fmac_f32 v78, v83, v37
    v_fma_f32 v79, -v82, v37, v79
    v_cvt_pk_bf16_f32 v142, v76, v77
    v_cvt_pk_bf16_f32 v146, v78, v79
    v_fmac_f32 v84, v88, v38
    v_fmac_f32 v85, v89, v38
    v_fmac_f32 v86, v90, v38
    v_fmac_f32 v87, v91, v38
    v_fmac_f32 v84, v89, v39
    v_fma_f32 v85, -v88, v39, v85
    v_fmac_f32 v86, v91, v39
    v_fma_f32 v87, -v90, v39, v87
    v_cvt_pk_bf16_f32 v143, v84, v85
    v_cvt_pk_bf16_f32 v147, v86, v87
    s_mul_i32 s6, s44, 8320
    buffer_store_dwordx4 v[140:143], v161, s[40:43], s6 offen offset:0 sc1
    buffer_store_dwordx4 v[144:147], v161, s[40:43], s6 offen offset:1024 sc1
    v_cvt_pk_bf16_f32 v120, v116, v117
    v_cvt_pk_bf16_f32 v121, v118, v119
    s_add_u32 s6, s96, 0x480000
    s_mov_b64 exec, s[50:51]
    buffer_store_dword v120, v162, s[40:43], s6 offen offset:0 sc1
    buffer_store_dword v121, v162, s[40:43], s6 offen offset:1024 sc1
    s_mov_b64 exec, -1
    s_cmp_eq_u32 s46, 7
    s_cbranch_scc1 LbF
    s_load_dwordx2 s[48:49], s[36:37], 0
    v_mov_b32 v60, 0
    v_mov_b32 v61, 0
    s_waitcnt vmcnt(8)
    v_dot2c_f32_bf16 v60, v48, v56
    v_dot2c_f32_bf16 v61, v52, v56
    s_waitcnt vmcnt(7)
    v_dot2c_f32_bf16 v60, v49, v57
    v_dot2c_f32_bf16 v61, v53, v57
    s_waitcnt vmcnt(6)
    v_dot2c_f32_bf16 v60, v50, v58
    v_dot2c_f32_bf16 v61, v54, v58
    s_waitcnt vmcnt(5)
    v_dot2c_f32_bf16 v60, v51, v59
    v_dot2c_f32_bf16 v61, v55, v59
    s_nop 1
    v_add_f32_dpp v60, v60, v60 row_shr:1 bound_ctrl:0
    v_add_f32_dpp v61, v61, v61 row_shr:1 bound_ctrl:0
    s_nop 0
    v_add_f32_dpp v60, v60, v60 row_shr:2 bound_ctrl:0
    v_add_f32_dpp v61, v61, v61 row_shr:2 bound_ctrl:0
    s_nop 0
    v_add_f32_dpp v60, v60, v60 row_shr:4 bound_ctrl:0
    v_add_f32_dpp v61, v61, v61 row_shr:4 bound_ctrl:0
    s_nop 0
    v_add_f32_dpp v60, v60, v60 row_shr:8 bound_ctrl:0
    v_add_f32_dpp v61, v61, v61 row_shr:8 bound_ctrl:0
    s_nop 0
    v_add_f32_dpp v60, v60, v60 row_bcast:15 row_mask:0xa
    v_add_f32_dpp v61, v61, v61 row_bcast:15 row_mask:0xa
    s_nop 0
    v_add_f32_dpp v60, v60, v60 row_bcast:31 row_mask:0xc
    v_add_f32_dpp v61, v61, v61 row_bcast:31 row_mask:0xc
    v_cvt_pk_bf16_f32 v64, v60, v61
    v_lshlrev_b32 v60, 16, v64
    v_and_b32 v61, 0xffff0000, v64
    v_mul_f32 v60, 0xbfb8aa3b, v60
    v_mul_f32 v61, 0xbfb8aa3b, v61
    v_exp_f32 v60, v60
    v_exp_f32 v61, v61
    v_add_f32 v60, 1.0, v60
    v_add_f32 v61, 1.0, v61
    v_rcp_f32 v60, v60
    v_rcp_f32 v61, v61
    s_nop 0
    v_cvt_pk_bf16_f32 v64, v60, v61
    v_lshlrev_b32 v60, 16, v64
    v_and_b32 v61, 0xffff0000, v64
    v_sub_f32 v62, 1.0, v60
    v_sub_f32 v63, 1.0, v61
    v_cvt_pk_bf16_f32 v64, v62, v63
    v_lshlrev_b32 v62, 16, v64
    v_and_b32 v63, 0xffff0000, v64
    v_mul_f32 v60, 0x35000000, v60
    v_mul_f32 v61, 0x35000000, v61
    v_readlane_b32 s52, v60, 63
    v_readlane_b32 s53, v61, 63
    s_lshl_b32 s6, s45, 3
    s_add_u32 s6, s6, 163136
    v_mov_b32 v4, s6
    s_mov_b32 exec_lo, 0
    s_brev_b32 exec_hi, 1
    ds_write_b64 v4, v[62:63]
    s_mov_b64 exec, -1
    v_lshlrev_b32 v4, 13, v1
    s_lshl_b32 s6, s45, 11
    s_bfe_u32 s7, s44, 0x30001
    s_lshl_b32 s7, s7, 8
    s_add_u32 s6, s6, s7
    s_lshr_b32 s7, s44, 4
    s_lshl_b32 s7, s7, 4
    s_add_u32 s6, s6, s7
    s_and_b32 s7, s44, 1
    s_lshl_b32 s7, s7, 3
    s_add_u32 s6, s6, s7
    s_add_u32 s6, s6, 0x488000
    s_waitcnt lgkmcnt(0)
    s_cmp_lg_u32 s48, 0
    s_cbranch_scc1 L3
    s_mov_b32 s92, 400000
L4:
    s_load_dwordx2 s[48:49], s[36:37], 0 glc
    s_waitcnt lgkmcnt(0)
    s_cmp_lg_u32 s48, 0
    s_cbranch_scc1 L3
    s_sleep 2
    s_sub_u32 s92, s92, 1
    s_cbranch_scc0 L4
L3:
    v_mov_b32 v24, s48
    v_mov_b32 v25, s49
    s_waitcnt vmcnt(0)
    s_mov_b64 exec, 0xff
    buffer_store_dwordx2 v[24:25], v4, s[40:43], s6 offen sc1
    s_mov_b64 exec, -1
    s_lshl3_add_u32 s6, s44, s45
    s_lshl_b32 s6, s6, 7
    s_add_u32 s6, s6, 0x4a0000
    s_load_dword s59, s[40:41], s6 glc
    s_add_u32 s7, s6, 512
    s_load_dword s59, s[40:41], s7 glc
    s_setprio 0
    v_mov_b32 v28, 2
    s_mov_b64 exec, 1
    ds_write_b32 v26, v28
    s_mov_b64 exec, -1
Lc:
    v_lshrrev_b32 v4, 1, v2
    v_lshlrev_b32 v4, 8, v4
    v_add_u32 v4, s44, v4
    v_and_b32 v5, 1, v2
    v_mul_u32_u24 v6, 0x600, v5
    v_lshlrev_b32 v7, 1, v3
    v_mad_u32_u24 v92, v4, v7, v6
    v_and_b32 v92, 0x7ff, v92
    v_add_u32 v7, 1, v7
    v_mad_u32_u24 v93, v4, v7, v6
    v_and_b32 v93, 0x7ff, v93
    s_lshl_b32 s6, s45, 6
    v_add_u32 v7, s6, v2
    v_add_u32 v96, 0, v7
    v_add_u32 v97, 16, v7
    v_add_u32 v98, 32, v7
    v_add_u32 v99, 48, v7
    v_cvt_f32_u32 v92, v92
    v_cvt_f32_u32 v93, v93
    v_cvt_f32_u32 v96, v96
    v_cvt_f32_u32 v97, v97
    v_cvt_f32_u32 v98, v98
    v_cvt_f32_u32 v99, v99
    v_mul_f32 v92, 0x3a000000, v92
    v_mul_f32 v93, 0x3a000000, v93
    v_mul_f32 v96, 0x3b000000, v96
    v_mul_f32 v97, 0x3b000000, v97
    v_mul_f32 v98, 0x3b000000, v98
    v_mul_f32 v99, 0x3b000000, v99
    v_cos_f32 v100, v92
    v_cos_f32 v101, v93
    v_cos_f32 v32, v96
    v_cos_f32 v34, v97
    v_cos_f32 v36, v98
    v_cos_f32 v38, v99
    v_sin_f32 v104, v92
    v_sin_f32 v105, v93
    v_sin_f32 v33, v96
    v_sin_f32 v35, v97
    v_sin_f32 v37, v98
    v_sin_f32 v39, v99
    s_mov_b32 s6, 0x80008000
    v_mul_lo_u32 v5, v5, s6
    v_cvt_pk_bf16_f32 v40, v100, -v104
    v_cvt_pk_bf16_f32 v41, v101, -v105
    v_mov_b32 v44, v40
    v_xor_b32 v42, v5, v40
    v_mov_b32 v45, v41
    v_xor_b32 v43, v5, v41
    v_xor_b32 v46, s6, v42
    v_xor_b32 v47, s6, v43
    s_movk_i32 s6, 2624
    v_mul_lo_u32 v4, v3, s6
    v_add_u32 v4, 149504, v4
    v_lshl_add_u32 v164, v7, 2, v4
    v_sub_u32 v5, 208, v7
    v_lshl_add_u32 v165, v5, 2, v4
    s_lshl_b32 s6, s45, 8
    s_add_u32 s6, s6, 139264
    v_lshlrev_b32 v4, 11, v3
    v_lshl_add_u32 v4, v2, 4, v4
    v_add_u32 v166, s6, v4
    s_lshr_b32 s6, s45, 1
    s_mul_i32 s6, s6, 2624
    s_and_b32 s7, s45, 1
    s_mul_i32 s7, s7, 1280
    s_add_u32 s6, s6, s7
    s_add_u32 s6, s6, 149504
    v_add_u32 v163, s6, v30
    s_movk_i32 s6, 528
    v_mul_lo_u32 v4, v2, s6
    v_lshl_add_u32 v4, v3, 7, v4
    s_lshl_b32 s7, s45, 5
    s_add_u32 s7, s7, 149504
    v_add_u32 v167, s7, v4
    v_lshlrev_b32 v169, 4, v0
    v_lshlrev_b32 v170, 3, v1
    s_bfe_u32 s6, s44, 0x30001
    s_lshl2_add_u32 s6, s6, s45
    s_lshl_b32 s6, s6, 7
    s_lshr_b32 s7, s44, 4
    s_and_b32 s7, s7, 3
    s_lshl_b32 s7, s7, 12
    s_add_u32 s6, s6, s7
    s_add_u32 s95, s6, 0x500000
    s_add_u32 s99, s95, 64
    s_lshl_b32 s7, s45, 10
    s_add_u32 s6, s96, s7
    s_add_u32 s96, s6, 0x484000
    v_lshlrev_b32 v174, 12, v1
    s_mul_i32 s6, s44, 8320
    s_add_u32 s97, s6, 0x240000
    s_add_u32 s98, s97, 4096
    s_movk_i32 s6, 5232
    v_mul_lo_u32 v5, v1, s6
    v_add_u32 v175, v5, v163
    s_cmp_eq_u32 s46, 7
    s_cbranch_scc1 Lc2
    s_bfe_u32 s6, s47, 0x10002
    s_lshl1_add_u32 s6, s47, s6
    s_cmp_eq_u32 s46, 3
    s_cselect_b32 s6, s6, s47
    s_and_b32 s58, s6, 7
    s_lshl_b32 s5, s45, 1
    s_sub_u32 s5, s5, s58
    s_and_b32 s6, s5, 7
    s_lshl_b32 s6, s6, 11
    s_add_u32 s6, s6, 65536
    v_add_u32 v156, s6, v30
    s_add_u32 s5, s5, 1
    s_and_b32 s6, s5, 7
    s_lshl_b32 s6, s6, 11
    s_add_u32 s6, s6, 65536
    v_add_u32 v157, s6, v30
    s_lshl_b32 s6, s45, 12
    s_add_u32 s6, s6, 139264
    v_add_u32 v158, s6, v30
    s_mov_b32 s92, 0x1000000
L5:
    s_sleep 1
    ds_read_b32 v28, v26 offset:16
    s_sub_u32 s92, s92, 1
    s_cbranch_scc1 L6
    s_waitcnt lgkmcnt(0)
    v_cmp_gt_u32 vcc, 4, v28
    s_cbranch_vccnz L5
L6:
    ds_read_b128 v[60:63], v156 offset:16384
    ds_read_b128 v[64:67], v158 offset:0
    ds_read_b128 v[68:71], v156 offset:17408
    ds_read_b128 v[72:75], v158 offset:1024
    ds_read_b128 v[76:79], v157 offset:16384
    ds_read_b128 v[80:83], v158 offset:2048
    ds_read_b128 v[84:87], v157 offset:17408
    ds_read_b128 v[88:91], v158 offset:3072
    s_waitcnt lgkmcnt(7)
    v_mul_f32 v92, 0xbfb8aa3b, v60
    v_mul_f32 v93, 0xbfb8aa3b, v61
    v_mul_f32 v94, 0xbfb8aa3b, v62
    v_mul_f32 v95, 0xbfb8aa3b, v63
    s_waitcnt lgkmcnt(6)
    v_mul_f32 v96, 0xbfb8aa3b, v64
    v_mul_f32 v97, 0xbfb8aa3b, v65
    v_mul_f32 v98, 0xbfb8aa3b, v66
    v_mul_f32 v99, 0xbfb8aa3b, v67
    v_exp_f32 v92, v92
    v_exp_f32 v93, v93
    v_exp_f32 v94, v94
    v_exp_f32 v95, v95
    v_exp_f32 v96, v96
    v_exp_f32 v97, v97
    v_exp_f32 v98, v98
    v_exp_f32 v99, v99
    v_add_f32 v92, 1.0, v92
    v_add_f32 v93, 1.0, v93
    v_add_f32 v94, 1.0, v94
    v_add_f32 v95, 1.0, v95
    v_add_f32 v96, 1.0, v96
    v_add_f32 v97, 1.0, v97
    v_add_f32 v98, 1.0, v98
    v_add_f32 v99, 1.0, v99
    v_rcp_f32 v92, v92
    v_rcp_f32 v93, v93
    v_rcp_f32 v94, v94
    v_rcp_f32 v95, v95
    v_rcp_f32 v96, v96
    v_rcp_f32 v97, v97
    v_rcp_f32 v98, v98
    v_rcp_f32 v99, v99
    v_mul_f32 v92, v92, v60
    v_mul_f32 v93, v93, v61
    v_mul_f32 v94, v94, v62
    v_mul_f32 v95, v95, v63
    v_mul_f32 v96, v96, v64
    v_mul_f32 v97, v97, v65
    v_mul_f32 v98, v98, v66
    v_mul_f32 v99, v99, v67
    v_cvt_pk_bf16_f32 v92, v92, v93
    v_cvt_pk_bf16_f32 v93, v94, v95
    v_cvt_pk_bf16_f32 v94, v96, v97
    v_cvt_pk_bf16_f32 v95, v98, v99
    ds_write_b128 v156, v[92:95] offset:16384
    s_waitcnt lgkmcnt(6)
    v_mul_f32 v100, 0xbfb8aa3b, v68
    v_mul_f32 v101, 0xbfb8aa3b, v69
    v_mul_f32 v102, 0xbfb8aa3b, v70
    v_mul_f32 v103, 0xbfb8aa3b, v71
    s_waitcnt lgkmcnt(5)
    v_mul_f32 v104, 0xbfb8aa3b, v72
    v_mul_f32 v105, 0xbfb8aa3b, v73
    v_mul_f32 v106, 0xbfb8aa3b, v74
    v_mul_f32 v107, 0xbfb8aa3b, v75
    v_exp_f32 v100, v100
    v_exp_f32 v101, v101
    v_exp_f32 v102, v102
    v_exp_f32 v103, v103
    v_exp_f32 v104, v104
    v_exp_f32 v105, v105
    v_exp_f32 v106, v106
    v_exp_f32 v107, v107
    v_add_f32 v100, 1.0, v100
    v_add_f32 v101, 1.0, v101
    v_add_f32 v102, 1.0, v102
    v_add_f32 v103, 1.0, v103
    v_add_f32 v104, 1.0, v104
    v_add_f32 v105, 1.0, v105
    v_add_f32 v106, 1.0, v106
    v_add_f32 v107, 1.0, v107
    v_rcp_f32 v100, v100
    v_rcp_f32 v101, v101
    v_rcp_f32 v102, v102
    v_rcp_f32 v103, v103
    v_rcp_f32 v104, v104
    v_rcp_f32 v105, v105
    v_rcp_f32 v106, v106
    v_rcp_f32 v107, v107
    v_mul_f32 v100, v100, v68
    v_mul_f32 v101, v101, v69
    v_mul_f32 v102, v102, v70
    v_mul_f32 v103, v103, v71
    v_mul_f32 v104, v104, v72
    v_mul_f32 v105, v105, v73
    v_mul_f32 v106, v106, v74
    v_mul_f32 v107, v107, v75
    v_cvt_pk_bf16_f32 v100, v100, v101
    v_cvt_pk_bf16_f32 v101, v102, v103
    v_cvt_pk_bf16_f32 v102, v104, v105
    v_cvt_pk_bf16_f32 v103, v106, v107
    ds_write_b128 v156, v[100:103] offset:17408
    s_waitcnt lgkmcnt(5)
    v_mul_f32 v108, 0xbfb8aa3b, v76
    v_mul_f32 v109, 0xbfb8aa3b, v77
    v_mul_f32 v110, 0xbfb8aa3b, v78
    v_mul_f32 v111, 0xbfb8aa3b, v79
    s_waitcnt lgkmcnt(4)
    v_mul_f32 v112, 0xbfb8aa3b, v80
    v_mul_f32 v113, 0xbfb8aa3b, v81
    v_mul_f32 v114, 0xbfb8aa3b, v82
    v_mul_f32 v115, 0xbfb8aa3b, v83
    v_exp_f32 v108, v108
    v_exp_f32 v109, v109
    v_exp_f32 v110, v110
    v_exp_f32 v111, v111
    v_exp_f32 v112, v112
    v_exp_f32 v113, v113
    v_exp_f32 v114, v114
    v_exp_f32 v115, v115
    v_add_f32 v108, 1.0, v108
    v_add_f32 v109, 1.0, v109
    v_add_f32 v110, 1.0, v110
    v_add_f32 v111, 1.0, v111
    v_add_f32 v112, 1.0, v112
    v_add_f32 v113, 1.0, v113
    v_add_f32 v114, 1.0, v114
    v_add_f32 v115, 1.0, v115
    v_rcp_f32 v108, v108
    v_rcp_f32 v109, v109
    v_rcp_f32 v110, v110
    v_rcp_f32 v111, v111
    v_rcp_f32 v112, v112
    v_rcp_f32 v113, v113
    v_rcp_f32 v114, v114
    v_rcp_f32 v115, v115
    v_mul_f32 v108, v108, v76
    v_mul_f32 v109, v109, v77
    v_mul_f32 v110, v110, v78
    v_mul_f32 v111, v111, v79
    v_mul_f32 v112, v112, v80
    v_mul_f32 v113, v113, v81
    v_mul_f32 v114, v114, v82
    v_mul_f32 v115, v115, v83
    v_cvt_pk_bf16_f32 v108, v108, v109
    v_cvt_pk_bf16_f32 v109, v110, v111
    v_cvt_pk_bf16_f32 v110, v112, v113
    v_cvt_pk_bf16_f32 v111, v114, v115
    ds_write_b128 v157, v[108:111] offset:16384
    s_waitcnt lgkmcnt(4)
    v_mul_f32 v116, 0xbfb8aa3b, v84
    v_mul_f32 v117, 0xbfb8aa3b, v85
    v_mul_f32 v118, 0xbfb8aa3b, v86
    v_mul_f32 v119, 0xbfb8aa3b, v87
    s_waitcnt lgkmcnt(3)
    v_mul_f32 v120, 0xbfb8aa3b, v88
    v_mul_f32 v121, 0xbfb8aa3b, v89
    v_mul_f32 v122, 0xbfb8aa3b, v90
    v_mul_f32 v123, 0xbfb8aa3b, v91
    v_exp_f32 v116, v116
    v_exp_f32 v117, v117
    v_exp_f32 v118, v118
    v_exp_f32 v119, v119
    v_exp_f32 v120, v120
    v_exp_f32 v121, v121
    v_exp_f32 v122, v122
    v_exp_f32 v123, v123
    v_add_f32 v116, 1.0, v116
    v_add_f32 v117, 1.0, v117
    v_add_f32 v118, 1.0, v118
    v_add_f32 v119, 1.0, v119
    v_add_f32 v120, 1.0, v120
    v_add_f32 v121, 1.0, v121
    v_add_f32 v122, 1.0, v122
    v_add_f32 v123, 1.0, v123
    v_rcp_f32 v116, v116
    v_rcp_f32 v117, v117
    v_rcp_f32 v118, v118
    v_rcp_f32 v119, v119
    v_rcp_f32 v120, v120
    v_rcp_f32 v121, v121
    v_rcp_f32 v122, v122
    v_rcp_f32 v123, v123
    v_mul_f32 v116, v116, v84
    v_mul_f32 v117, v117, v85
    v_mul_f32 v118, v118, v86
    v_mul_f32 v119, v119, v87
    v_mul_f32 v120, v120, v88
    v_mul_f32 v121, v121, v89
    v_mul_f32 v122, v122, v90
    v_mul_f32 v123, v123, v91
    v_cvt_pk_bf16_f32 v116, v116, v117
    v_cvt_pk_bf16_f32 v117, v118, v119
    v_cvt_pk_bf16_f32 v118, v120, v121
    v_cvt_pk_bf16_f32 v119, v122, v123
    ds_write_b128 v157, v[116:119] offset:17408
    v_mov_b32 v28, 3
    s_mov_b64 exec, 1
    ds_write_b32 v26, v28
    s_mov_b64 exec, -1
    s_mov_b32 s92, 0x1000000
L7:
    s_sleep 1
    ds_read_b32 v28, v27 offset:0
    s_sub_u32 s92, s92, 1
    s_cbranch_scc1 L8
    s_waitcnt lgkmcnt(0)
    v_cmp_gt_u32 vcc, 3, v28
    s_cbranch_vccnz L7
L8:
Lc2:
    s_setprio 1
    s_mov_b32 s92, 400000
L9:
    s_load_dwordx16 s[8:23], s[40:41], s95 glc
    s_load_dwordx4 s[24:27], s[40:41], s99 glc
    s_waitcnt lgkmcnt(0)
    s_xor_b64 s[8:9], s[8:9], s[48:49]
    s_xor_b64 s[10:11], s[10:11], s[48:49]
    s_or_b64 s[8:9], s[8:9], s[10:11]
    s_xor_b64 s[12:13], s[12:13], s[48:49]
    s_or_b64 s[8:9], s[8:9], s[12:13]
    s_xor_b64 s[14:15], s[14:15], s[48:49]
    s_or_b64 s[8:9], s[8:9], s[14:15]
    s_xor_b64 s[16:17], s[16:17], s[48:49]
    s_or_b64 s[8:9], s[8:9], s[16:17]
    s_xor_b64 s[18:19], s[18:19], s[48:49]
    s_or_b64 s[8:9], s[8:9], s[18:19]
    s_xor_b64 s[20:21], s[20:21], s[48:49]
    s_or_b64 s[8:9], s[8:9], s[20:21]
    s_xor_b64 s[22:23], s[22:23], s[48:49]
    s_or_b64 s[8:9], s[8:9], s[22:23]
    s_xor_b64 s[24:25], s[24:25], s[48:49]
    s_or_b64 s[8:9], s[8:9], s[24:25]
    s_xor_b64 s[26:27], s[26:27], s[48:49]
    s_or_b64 s[8:9], s[8:9], s[26:27]
    s_cbranch_scc0 L10
    s_sleep 2
    s_sub_u32 s92, s92, 1
    s_cbranch_scc0 L9
L10:
    buffer_load_dwordx4 v[92:95], v169, s[40:43], s97 offen sc1
    buffer_load_dwordx4 v[96:99], v169, s[40:43], s98 offen sc1
    s_mov_b64 exec, 3
    buffer_load_dword v100, v174, s[40:43], s96 offen sc1
    s_mov_b64 exec, -1
    s_waitcnt vmcnt(2)
    ds_write_b128 v163, v[92:95]
    s_waitcnt vmcnt(1)
    ds_write_b128 v163, v[96:99] offset:5248
    s_mov_b64 exec, 3
    s_waitcnt vmcnt(0)
    ds_write_b32 v175, v100 offset:1024
    s_mov_b64 exec, -1
    v_mov_b32 v28, 4
    s_mov_b64 exec, 1
    ds_write_b32 v26, v28
    s_mov_b64 exec, -1
    v_add_u32 v109, 64, v164
    v_add_u32 v113, 64, v165
    v_add_u32 v110, 128, v164
    v_add_u32 v114, 128, v165
    v_add_u32 v111, 192, v164
    v_add_u32 v115, 192, v165
    s_mov_b32 s92, 0x1000000
L11:
    ds_read_b32 v28, v27 offset:0
    ds_read2st64_b32 v[124:125], v164 offset0:0 offset1:5
    ds_read2st64_b32 v[126:127], v115 offset0:0 offset1:5
    ds_read2st64_b32 v[128:129], v109 offset0:0 offset1:5
    ds_read2st64_b32 v[130:131], v114 offset0:0 offset1:5
    ds_read2st64_b32 v[132:133], v110 offset0:0 offset1:5
    ds_read2st64_b32 v[134:135], v113 offset0:0 offset1:5
    ds_read2st64_b32 v[136:137], v111 offset0:0 offset1:5
    ds_read2st64_b32 v[138:139], v165 offset0:0 offset1:5
    s_sub_u32 s92, s92, 1
    s_cbranch_scc1 L12
    s_waitcnt lgkmcnt(8)
    v_cmp_gt_u32 vcc, 4, v28
    s_cbranch_vccnz L11
L12:
    s_waitcnt lgkmcnt(6)
    v_mfma_f32_16x16x32_bf16 v[60:63], v[40:43], v[124:127], 0
    v_mfma_f32_16x16x32_bf16 v[64:67], v[44:47], v[124:127], 0
    s_waitcnt lgkmcnt(4)
    v_mfma_f32_16x16x32_bf16 v[68:71], v[40:43], v[128:131], 0
    v_mfma_f32_16x16x32_bf16 v[72:75], v[44:47], v[128:131], 0
    s_waitcnt lgkmcnt(2)
    v_mfma_f32_16x16x32_bf16 v[76:79], v[40:43], v[132:135], 0
    v_mfma_f32_16x16x32_bf16 v[80:83], v[44:47], v[132:135], 0
    s_waitcnt lgkmcnt(0)
    v_mfma_f32_16x16x32_bf16 v[84:87], v[40:43], v[136:139], 0
    v_mfma_f32_16x16x32_bf16 v[88:91], v[44:47], v[136:139], 0
    v_cndmask_b32_e64 v61, v61, 0, s[50:51]
    v_cndmask_b32_e64 v65, v65, 0, s[50:51]
    v_cndmask_b32_e64 v63, v63, 0, s[50:51]
    v_cndmask_b32_e64 v67, v67, 0, s[50:51]
    v_fma_f32 v60, -v64, v33, v60
    v_fma_f32 v61, -v65, v33, v61
    v_fma_f32 v62, -v66, v33, v62
    v_fma_f32 v63, -v67, v33, v63
    v_fma_f32 v60, -v65, v32, v60
    v_fma_f32 v61, v64, v32, v61
    v_fma_f32 v62, -v67, v32, v62
    v_fma_f32 v63, v66, v32, v63
    v_cvt_pk_bf16_f32 v140, v61, v60
    v_cvt_pk_bf16_f32 v144, v63, v62
    v_fma_f32 v68, -v72, v35, v68
    v_fma_f32 v69, -v73, v35, v69
    v_fma_f32 v70, -v74, v35, v70
    v_fma_f32 v71, -v75, v35, v71
    v_fma_f32 v68, -v73, v34, v68
    v_fma_f32 v69, v72, v34, v69
    v_fma_f32 v70, -v75, v34, v70
    v_fma_f32 v71, v74, v34, v71
    v_cvt_pk_bf16_f32 v141, v69, v68
    v_cvt_pk_bf16_f32 v145, v71, v70
    v_fma_f32 v76, -v80, v37, v76
    v_fma_f32 v77, -v81, v37, v77
    v_fma_f32 v78, -v82, v37, v78
    v_fma_f32 v79, -v83, v37, v79
    v_fma_f32 v76, -v81, v36, v76
    v_fma_f32 v77, v80, v36, v77
    v_fma_f32 v78, -v83, v36, v78
    v_fma_f32 v79, v82, v36, v79
    v_cvt_pk_bf16_f32 v142, v77, v76
    v_cvt_pk_bf16_f32 v146, v79, v78
    v_fma_f32 v84, -v88, v39, v84
    v_fma_f32 v85, -v89, v39, v85
    v_fma_f32 v86, -v90, v39, v86
    v_fma_f32 v87, -v91, v39, v87
    v_fma_f32 v84, -v89, v38, v84
    v_fma_f32 v85, v88, v38, v85
    v_fma_f32 v86, -v91, v38, v86
    v_fma_f32 v87, v90, v38, v87
    v_cvt_pk_bf16_f32 v143, v85, v84
    v_cvt_pk_bf16_f32 v147, v87, v86
    ds_write_b128 v166, v[140:143] offset:0
    ds_write_b128 v166, v[144:147] offset:1024
    v_mov_b32 v28, 5
    s_mov_b64 exec, 1
    ds_write_b32 v26, v28
    s_mov_b64 exec, -1
    s_lshl_b32 s6, s45, 11
    s_add_u32 s6, s6, 139264
    v_add_u32 v4, s6, v30
    s_mov_b32 s92, 0x1000000
L13:
    ds_read_b32 v28, v27 offset:0
    ds_read_b128 v[48:51], v4
    ds_read_b128 v[52:55], v4 offset:1024
    s_sub_u32 s92, s92, 1
    s_cbranch_scc1 L14
    s_waitcnt lgkmcnt(2)
    v_cmp_gt_u32 vcc, 5, v28
    s_cbranch_vccnz L13
L14:
    s_waitcnt lgkmcnt(1)
    v_mfma_f32_16x16x32_bf16 v[60:63], v[48:51], v[8:11], 0
    v_mfma_f32_16x16x32_bf16 v[64:67], v[48:51], v[12:15], 0
    s_waitcnt lgkmcnt(0)
    v_mfma_f32_16x16x32_bf16 v[68:71], v[52:55], v[8:11], 0
    v_mfma_f32_16x16x32_bf16 v[72:75], v[52:55], v[12:15], 0
    s_nop 3
    v_mul_f32 v92, v60, v16
    v_mul_f32 v93, v61, v17
    v_mul_f32 v94, v62, v18
    v_mul_f32 v95, v63, v19
    v_mul_f32 v96, v64, v16
    v_mul_f32 v97, v65, v17
    v_mul_f32 v98, v66, v18
    v_mul_f32 v99, v67, v19
    v_fmac_f32 v92, v64, v20
    v_fmac_f32 v93, v65, v21
    v_fmac_f32 v94, v66, v22
    v_fmac_f32 v95, v67, v23
    v_fma_f32 v96, -v60, v20, v96
    v_fma_f32 v97, -v61, v21, v97
    v_fma_f32 v98, -v62, v22, v98
    v_fma_f32 v99, -v63, v23, v99
    v_cvt_pk_bf16_f32 v124, v92, v96
    v_cvt_pk_bf16_f32 v125, v93, v97
    v_cvt_pk_bf16_f32 v126, v94, v98
    v_cvt_pk_bf16_f32 v127, v95, v99
    v_mul_f32 v100, v68, v16
    v_mul_f32 v101, v69, v17
    v_mul_f32 v102, v70, v18
    v_mul_f32 v103, v71, v19
    v_mul_f32 v104, v72, v16
    v_mul_f32 v105, v73, v17
    v_mul_f32 v106, v74, v18
    v_mul_f32 v107, v75, v19
    v_fmac_f32 v100, v72, v20
    v_fmac_f32 v101, v73, v21
    v_fmac_f32 v102, v74, v22
    v_fmac_f32 v103, v75, v23
    v_fma_f32 v104, -v68, v20, v104
    v_fma_f32 v105, -v69, v21, v105
    v_fma_f32 v106, -v70, v22, v106
    v_fma_f32 v107, -v71, v23, v107
    v_cvt_pk_bf16_f32 v128, v100, v104
    v_cvt_pk_bf16_f32 v129, v101, v105
    v_cvt_pk_bf16_f32 v130, v102, v106
    v_cvt_pk_bf16_f32 v131, v103, v107
    v_mfma_f32_16x16x32_bf16 v[76:79], v[124:127], v[8:11], 0
    v_mfma_f32_16x16x32_bf16 v[80:83], v[124:127], v[12:15], 0
    v_mfma_f32_16x16x32_bf16 v[84:87], v[128:131], v[8:11], 0
    v_mfma_f32_16x16x32_bf16 v[88:91], v[128:131], v[12:15], 0
    s_nop 4
    v_mul_f32 v76, s52, v76
    v_mul_f32 v80, s52, v80
    v_mul_f32 v77, s52, v77
    v_mul_f32 v81, s52, v81
    v_mul_f32 v78, s52, v78
    v_mul_f32 v82, s52, v82
    v_mul_f32 v79, s52, v79
    v_mul_f32 v83, s52, v83
    v_cvt_pk_bf16_f32 v140, v80, v76
    v_cvt_pk_bf16_f32 v141, v81, v77
    v_cvt_pk_bf16_f32 v142, v82, v78
    v_cvt_pk_bf16_f32 v143, v83, v79
    ds_write_b128 v167, v[140:143] offset:0
    v_mul_f32 v84, s53, v84
    v_mul_f32 v88, s53, v88
    v_mul_f32 v85, s53, v85
    v_mul_f32 v89, s53, v89
    v_mul_f32 v86, s53, v86
    v_mul_f32 v90, s53, v90
    v_mul_f32 v87, s53, v87
    v_mul_f32 v91, s53, v91
    v_cvt_pk_bf16_f32 v144, v88, v84
    v_cvt_pk_bf16_f32 v145, v89, v85
    v_cvt_pk_bf16_f32 v146, v90, v86
    v_cvt_pk_bf16_f32 v147, v91, v87
    ds_write_b128 v167, v[144:147] offset:16
    v_mov_b32 v28, 6
    s_mov_b64 exec, 1
    ds_write_b32 v26, v28
    s_mov_b64 exec, -1
    s_waitcnt lgkmcnt(0)
    s_endpgm
Lbhi:
    s_load_dwordx2 s[12:13], s[0:1], 8
    s_load_dwordx2 s[16:17], s[0:1], 16
    s_load_dwordx2 s[36:37], s[0:1], 64
    s_mov_b32 s14, 0x101000
    s_mov_b32 s15, 0x20000
    s_mov_b32 s18, 0x101000
    s_mov_b32 s19, 0x20000
    s_mov_b32 s42, 0x10000000
    s_mov_b32 s43, 0x20000
    v_mov_b32 v29, 0
    v_mov_b32 v31, 0x20000
    v_lshrrev_b32 v4, 4, v0
    v_and_b32 v4, 28, v4
    v_add_u32 v26, 163072, v4
    v_and_b32 v4, 3, v1
    v_lshlrev_b32 v4, 2, v4
    v_add_u32 v27, 163072, v4
    s_mov_b32 s4, 263168
    v_mul_lo_u32 v249, v3, s4
    v_lshl_add_u32 v249, v2, 3, v249
    s_lshr_b32 s6, s47, 2
    s_mul_i32 s6, s6, 514
    s_and_b32 s4, s6, -4
    s_and_b32 s5, s47, 3
    s_lshl_b32 s5, s5, 7
    s_add_u32 s4, s4, s5
    s_mul_i32 s5, s3, 8224
    s_add_u32 s4, s4, s5
    s_waitcnt lgkmcnt(0)
    s_lshl2_add_u32 s5, s47, s45
    s_lshl_b32 s54, s5, 9
    s_add_u32 s54, s54, 0x488000
    s_lshl_b32 s5, s5, 6
    s_add_u32 s5, s5, 0x480000
    s_load_dword s59, s[40:41], s5 glc
    s_load_dword s59, s[40:41], s54 glc
    s_add_u32 s7, s54, 64
    s_load_dword s59, s[40:41], s7 glc
    s_add_u32 s7, s54, 128
    s_load_dword s59, s[40:41], s7 glc
    s_add_u32 s7, s54, 192
    s_load_dword s59, s[40:41], s7 glc
    s_add_u32 s7, s54, 256
    s_load_dword s59, s[40:41], s7 glc
    s_add_u32 s7, s54, 320
    s_load_dword s59, s[40:41], s7 glc
    s_add_u32 s7, s54, 384
    s_load_dword s59, s[40:41], s7 glc
    s_add_u32 s7, s54, 448
    s_load_dword s59, s[40:41], s7 glc
    s_add_u32 s5, s4, 0
    buffer_load_dwordx3 v[96:98], v249, s[12:15], s5 offen
    buffer_load_dwordx3 v[100:102], v249, s[16:19], s5 offen
    s_add_u32 s5, s4, 65792
    buffer_load_dwordx3 v[104:106], v249, s[12:15], s5 offen
    buffer_load_dwordx3 v[108:110], v249, s[16:19], s5 offen
    s_add_u32 s5, s4, 131584
    buffer_load_dwordx3 v[112:114], v249, s[12:15], s5 offen
    buffer_load_dwordx3 v[116:118], v249, s[16:19], s5 offen
    s_add_u32 s5, s4, 197376
    buffer_load_dwordx3 v[120:122], v249, s[12:15], s5 offen
    buffer_load_dwordx3 v[124:126], v249, s[16:19], s5 offen
    s_add_u32 s5, s4, 4112
    buffer_load_dwordx3 v[148:150], v249, s[12:15], s5 offen
    buffer_load_dwordx3 v[152:154], v249, s[16:19], s5 offen
    s_add_u32 s5, s4, 69904
    buffer_load_dwordx3 v[156:158], v249, s[12:15], s5 offen
    buffer_load_dwordx3 v[160:162], v249, s[16:19], s5 offen
    s_add_u32 s5, s4, 135696
    buffer_load_dwordx3 v[164:166], v249, s[12:15], s5 offen
    buffer_load_dwordx3 v[168:170], v249, s[16:19], s5 offen
    s_add_u32 s5, s4, 201488
    buffer_load_dwordx3 v[172:174], v249, s[12:15], s5 offen
    buffer_load_dwordx3 v[176:178], v249, s[16:19], s5 offen
    v_lshlrev_b32 v4, 2, v3
    v_add_u32 v5, 0, v4
    v_mul_u32_u24 v212, v5, v2
    v_add_u32 v5, 1, v4
    v_mul_u32_u24 v213, v5, v2
    v_add_u32 v5, 2, v4
    v_mul_u32_u24 v214, v5, v2
    v_add_u32 v5, 3, v4
    v_mul_u32_u24 v215, v5, v2
    v_and_b32 v216, 15, v212
    v_and_b32 v217, 15, v213
    v_and_b32 v218, 15, v214
    v_and_b32 v219, 15, v215
    v_cvt_f32_u32 v216, v216
    v_cvt_f32_u32 v217, v217
    v_cvt_f32_u32 v218, v218
    v_cvt_f32_u32 v219, v219
    v_mul_f32 v216, 0x3d800000, v216
    v_mul_f32 v217, 0x3d800000, v217
    v_mul_f32 v218, 0x3d800000, v218
    v_mul_f32 v219, 0x3d800000, v219
    v_cos_f32 v220, v216
    v_cos_f32 v221, v217
    v_cos_f32 v222, v218
    v_cos_f32 v223, v219
    v_sin_f32 v224, v216
    v_sin_f32 v225, v217
    v_sin_f32 v226, v218
    v_sin_f32 v227, v219
    v_cvt_pk_bf16_f32 v8, v220, v224
    v_cvt_pk_bf16_f32 v12, -v224, v220
    v_cvt_pk_bf16_f32 v9, v221, v225
    v_cvt_pk_bf16_f32 v13, -v225, v221
    v_cvt_pk_bf16_f32 v10, v222, v226
    v_cvt_pk_bf16_f32 v14, -v226, v222
    v_cvt_pk_bf16_f32 v11, v223, v227
    v_cvt_pk_bf16_f32 v15, -v227, v223
    s_lshl_b32 s7, s3, 1
    v_lshl_add_u32 v5, v2, 4, s7
    v_lshlrev_b32 v6, 2, v3
    v_lshl_add_u32 v7, v3, 6, s7
    v_add_u32 v212, 0, v6
    v_add_u32 v216, 0, v7
    v_add_u32 v213, 1, v6
    v_add_u32 v217, 16, v7
    v_add_u32 v214, 2, v6
    v_add_u32 v218, 32, v7
    v_add_u32 v215, 3, v6
    v_add_u32 v219, 48, v7
    v_mul_u32_u24 v212, v212, v5
    v_mul_u32_u24 v216, v216, v2
    v_mul_u32_u24 v213, v213, v5
    v_mul_u32_u24 v217, v217, v2
    v_mul_u32_u24 v214, v214, v5
    v_mul_u32_u24 v218, v218, v2
    v_mul_u32_u24 v215, v215, v5
    v_mul_u32_u24 v219, v219, v2
    v_cvt_f32_ubyte0 v212, v212
    v_cvt_f32_ubyte0 v213, v213
    v_cvt_f32_ubyte0 v214, v214
    v_cvt_f32_ubyte0 v215, v215
    v_cvt_f32_ubyte0 v216, v216
    v_cvt_f32_ubyte0 v217, v217
    v_cvt_f32_ubyte0 v218, v218
    v_cvt_f32_ubyte0 v219, v219
    v_mul_f32 v212, 0x3b800000, v212
    v_mul_f32 v213, 0x3b800000, v213
    v_mul_f32 v214, 0x3b800000, v214
    v_mul_f32 v215, 0x3b800000, v215
    v_mul_f32 v216, 0x3b800000, v216
    v_mul_f32 v217, 0x3b800000, v217
    v_mul_f32 v218, 0x3b800000, v218
    v_mul_f32 v219, 0x3b800000, v219
    v_cos_f32 v220, v212
    v_cos_f32 v221, v213
    v_cos_f32 v222, v214
    v_cos_f32 v223, v215
    v_cos_f32 v224, v216
    v_cos_f32 v225, v217
    v_cos_f32 v226, v218
    v_cos_f32 v227, v219
    v_sin_f32 v228, v212
    v_sin_f32 v229, v213
    v_sin_f32 v230, v214
    v_sin_f32 v231, v215
    v_sin_f32 v232, v216
    v_sin_f32 v233, v217
    v_sin_f32 v234, v218
    v_sin_f32 v235, v219
    v_cvt_pk_bf16_f32 v180, v220, v228
    v_cvt_pk_bf16_f32 v184, -v228, v220
    v_cvt_pk_bf16_f32 v188, v224, -v232
    v_cvt_pk_bf16_f32 v192, v232, v224
    v_cvt_pk_bf16_f32 v181, v221, v229
    v_cvt_pk_bf16_f32 v185, -v229, v221
    v_cvt_pk_bf16_f32 v189, v225, -v233
    v_cvt_pk_bf16_f32 v193, v233, v225
    v_cvt_pk_bf16_f32 v182, v222, v230
    v_cvt_pk_bf16_f32 v186, -v230, v222
    v_cvt_pk_bf16_f32 v190, v226, -v234
    v_cvt_pk_bf16_f32 v194, v234, v226
    v_cvt_pk_bf16_f32 v183, v223, v231
    v_cvt_pk_bf16_f32 v187, -v231, v223
    v_cvt_pk_bf16_f32 v191, v227, -v235
    v_cvt_pk_bf16_f32 v195, v235, v227
    v_add_u32 v5, 1, v5
    v_add_u32 v212, 0, v6
    v_add_u32 v216, 1, v7
    v_add_u32 v213, 1, v6
    v_add_u32 v217, 17, v7
    v_add_u32 v214, 2, v6
    v_add_u32 v218, 33, v7
    v_add_u32 v215, 3, v6
    v_add_u32 v219, 49, v7
    v_mul_u32_u24 v212, v212, v5
    v_mul_u32_u24 v216, v216, v2
    v_mul_u32_u24 v213, v213, v5
    v_mul_u32_u24 v217, v217, v2
    v_mul_u32_u24 v214, v214, v5
    v_mul_u32_u24 v218, v218, v2
    v_mul_u32_u24 v215, v215, v5
    v_mul_u32_u24 v219, v219, v2
    v_cvt_f32_ubyte0 v212, v212
    v_cvt_f32_ubyte0 v213, v213
    v_cvt_f32_ubyte0 v214, v214
    v_cvt_f32_ubyte0 v215, v215
    v_cvt_f32_ubyte0 v216, v216
    v_cvt_f32_ubyte0 v217, v217
    v_cvt_f32_ubyte0 v218, v218
    v_cvt_f32_ubyte0 v219, v219
    v_mul_f32 v212, 0x3b800000, v212
    v_mul_f32 v213, 0x3b800000, v213
    v_mul_f32 v214, 0x3b800000, v214
    v_mul_f32 v215, 0x3b800000, v215
    v_mul_f32 v216, 0x3b800000, v216
    v_mul_f32 v217, 0x3b800000, v217
    v_mul_f32 v218, 0x3b800000, v218
    v_mul_f32 v219, 0x3b800000, v219
    v_cos_f32 v220, v212
    v_cos_f32 v221, v213
    v_cos_f32 v222, v214
    v_cos_f32 v223, v215
    v_cos_f32 v224, v216
    v_cos_f32 v225, v217
    v_cos_f32 v226, v218
    v_cos_f32 v227, v219
    v_sin_f32 v228, v212
    v_sin_f32 v229, v213
    v_sin_f32 v230, v214
    v_sin_f32 v231, v215
    v_sin_f32 v232, v216
    v_sin_f32 v233, v217
    v_sin_f32 v234, v218
    v_sin_f32 v235, v219
    v_cvt_pk_bf16_f32 v196, v220, v228
    v_cvt_pk_bf16_f32 v200, -v228, v220
    v_cvt_pk_bf16_f32 v204, v224, -v232
    v_cvt_pk_bf16_f32 v208, v232, v224
    v_cvt_pk_bf16_f32 v197, v221, v229
    v_cvt_pk_bf16_f32 v201, -v229, v221
    v_cvt_pk_bf16_f32 v205, v225, -v233
    v_cvt_pk_bf16_f32 v209, v233, v225
    v_cvt_pk_bf16_f32 v198, v222, v230
    v_cvt_pk_bf16_f32 v202, -v230, v222
    v_cvt_pk_bf16_f32 v206, v226, -v234
    v_cvt_pk_bf16_f32 v210, v234, v226
    v_cvt_pk_bf16_f32 v199, v223, v231
    v_cvt_pk_bf16_f32 v203, -v231, v223
    v_cvt_pk_bf16_f32 v207, v227, -v235
    v_cvt_pk_bf16_f32 v211, v235, v227
    s_load_dwordx2 s[48:49], s[36:37], 0
    s_waitcnt lgkmcnt(0)
    s_cmp_lg_u32 s48, 0
    s_cbranch_scc1 L25
    s_mov_b32 s92, 400000
L26:
    s_load_dwordx2 s[48:49], s[36:37], 0 glc
    s_waitcnt lgkmcnt(0)
    s_cmp_lg_u32 s48, 0
    s_cbranch_scc1 L25
    s_sleep 2
    s_sub_u32 s92, s92, 1
    s_cbranch_scc0 L26
L25:
    v_mov_b32 v24, s48
    v_mov_b32 v25, s49
    s_setprio 2
    s_branch LbD
LbF:
    s_mov_b32 s14, 0x101000
    s_mov_b32 s15, 0x20000
    s_mov_b32 s18, 0x101000
    s_mov_b32 s19, 0x20000
    s_mov_b32 s4, 263168
    v_mul_lo_u32 v249, v3, s4
    v_lshl_add_u32 v249, v2, 3, v249
    s_lshr_b32 s6, s47, 2
    s_mul_i32 s6, s6, 514
    s_and_b32 s4, s6, -4
    s_and_b32 s5, s47, 3
    s_lshl_b32 s5, s5, 7
    s_add_u32 s4, s4, s5
    s_mul_i32 s5, s3, 8224
    s_add_u32 s4, s4, s5
    s_load_dwordx2 s[48:49], s[36:37], 0
    s_add_u32 s5, s4, 0
    buffer_load_dwordx3 v[96:98], v249, s[12:15], s5 offen
    v_mov_b32 v60, 0
    v_mov_b32 v61, 0
    s_waitcnt vmcnt(9)
    v_dot2c_f32_bf16 v60, v48, v56
    v_dot2c_f32_bf16 v61, v52, v56
    s_waitcnt vmcnt(8)
    v_dot2c_f32_bf16 v60, v49, v57
    v_dot2c_f32_bf16 v61, v53, v57
    s_waitcnt vmcnt(7)
    v_dot2c_f32_bf16 v60, v50, v58
    v_dot2c_f32_bf16 v61, v54, v58
    s_waitcnt vmcnt(6)
    v_dot2c_f32_bf16 v60, v51, v59
    v_dot2c_f32_bf16 v61, v55, v59
    s_nop 1
    v_add_f32_dpp v60, v60, v60 row_shr:1 bound_ctrl:0
    v_add_f32_dpp v61, v61, v61 row_shr:1 bound_ctrl:0
    s_nop 0
    v_add_f32_dpp v60, v60, v60 row_shr:2 bound_ctrl:0
    v_add_f32_dpp v61, v61, v61 row_shr:2 bound_ctrl:0
    s_nop 0
    v_add_f32_dpp v60, v60, v60 row_shr:4 bound_ctrl:0
    v_add_f32_dpp v61, v61, v61 row_shr:4 bound_ctrl:0
    buffer_load_dwordx3 v[100:102], v249, s[16:19], s5 offen
    v_add_f32_dpp v60, v60, v60 row_shr:8 bound_ctrl:0
    v_add_f32_dpp v61, v61, v61 row_shr:8 bound_ctrl:0
    s_nop 0
    v_add_f32_dpp v60, v60, v60 row_bcast:15 row_mask:0xa
    v_add_f32_dpp v61, v61, v61 row_bcast:15 row_mask:0xa
    s_nop 0
    v_add_f32_dpp v60, v60, v60 row_bcast:31 row_mask:0xc
    v_add_f32_dpp v61, v61, v61 row_bcast:31 row_mask:0xc
    v_cvt_pk_bf16_f32 v64, v60, v61
    v_lshlrev_b32 v60, 16, v64
    v_and_b32 v61, 0xffff0000, v64
    v_mul_f32 v60, 0xbfb8aa3b, v60
    v_mul_f32 v61, 0xbfb8aa3b, v61
    v_exp_f32 v60, v60
    v_exp_f32 v61, v61
    v_add_f32 v60, 1.0, v60
    v_add_f32 v61, 1.0, v61
    s_add_u32 s5, s4, 65792
    buffer_load_dwordx3 v[104:106], v249, s[12:15], s5 offen
    v_rcp_f32 v60, v60
    v_rcp_f32 v61, v61
    s_nop 0
    v_cvt_pk_bf16_f32 v64, v60, v61
    v_lshlrev_b32 v60, 16, v64
    v_and_b32 v61, 0xffff0000, v64
    v_sub_f32 v62, 1.0, v60
    v_sub_f32 v63, 1.0, v61
    v_cvt_pk_bf16_f32 v64, v62, v63
    v_lshlrev_b32 v62, 16, v64
    v_and_b32 v63, 0xffff0000, v64
    v_mul_f32 v60, 0x35000000, v60
    v_mul_f32 v61, 0x35000000, v61
    v_readlane_b32 s52, v60, 63
    v_readlane_b32 s53, v61, 63
    s_lshl_b32 s6, s45, 3
    buffer_load_dwordx3 v[108:110], v249, s[16:19], s5 offen
    s_add_u32 s6, s6, 163136
    v_mov_b32 v4, s6
    s_mov_b32 exec_lo, 0
    s_brev_b32 exec_hi, 1
    ds_write_b64 v4, v[62:63]
    s_mov_b64 exec, -1
    s_lshl_b32 s7, s3, 1
    v_lshl_add_u32 v5, v2, 4, s7
    v_lshlrev_b32 v6, 2, v3
    v_lshl_add_u32 v7, v3, 6, s7
    v_add_u32 v212, 0, v6
    v_add_u32 v216, 0, v7
    v_add_u32 v213, 1, v6
    v_add_u32 v217, 16, v7
    v_add_u32 v214, 2, v6
    v_add_u32 v218, 32, v7
    s_add_u32 s5, s4, 131584
    buffer_load_dwordx3 v[112:114], v249, s[12:15], s5 offen
    v_add_u32 v215, 3, v6
    v_add_u32 v219, 48, v7
    v_mul_u32_u24 v212, v212, v5
    v_mul_u32_u24 v216, v216, v2
    v_mul_u32_u24 v213, v213, v5
    v_mul_u32_u24 v217, v217, v2
    v_mul_u32_u24 v214, v214, v5
    v_mul_u32_u24 v218, v218, v2
    v_mul_u32_u24 v215, v215, v5
    v_mul_u32_u24 v219, v219, v2
    v_cvt_f32_ubyte0 v212, v212
    v_cvt_f32_ubyte0 v213, v213
    v_cvt_f32_ubyte0 v214, v214
    v_cvt_f32_ubyte0 v215, v215
    v_cvt_f32_ubyte0 v216, v216
    buffer_load_dwordx3 v[116:118], v249, s[16:19], s5 offen
    v_cvt_f32_ubyte0 v217, v217
    v_cvt_f32_ubyte0 v218, v218
    v_cvt_f32_ubyte0 v219, v219
    v_mul_f32 v212, 0x3b800000, v212
    v_mul_f32 v213, 0x3b800000, v213
    v_mul_f32 v214, 0x3b800000, v214
    v_mul_f32 v215, 0x3b800000, v215
    v_mul_f32 v216, 0x3b800000, v216
    v_mul_f32 v217, 0x3b800000, v217
    v_mul_f32 v218, 0x3b800000, v218
    v_mul_f32 v219, 0x3b800000, v219
    v_cos_f32 v220, v212
    v_cos_f32 v221, v213
    v_cos_f32 v222, v214
    v_cos_f32 v223, v215
    v_lshlrev_b32 v4, 13, v1
    s_lshl_b32 s6, s45, 11
    s_bfe_u32 s7, s44, 0x30001
    s_lshl_b32 s7, s7, 8
    s_add_u32 s6, s6, s7
    s_lshr_b32 s7, s44, 4
    s_lshl_b32 s7, s7, 4
    s_add_u32 s6, s6, s7
    s_and_b32 s7, s44, 1
    s_lshl_b32 s7, s7, 3
    s_add_u32 s6, s6, s7
    s_add_u32 s6, s6, 0x488000
    s_waitcnt lgkmcnt(0)
    s_cmp_lg_u32 s48, 0
    s_cbranch_scc1 L27
    s_mov_b32 s92, 400000
L28:
    s_load_dwordx2 s[48:49], s[36:37], 0 glc
    s_waitcnt lgkmcnt(0)
    s_cmp_lg_u32 s48, 0
    s_cbranch_scc1 L27
    s_sleep 2
    s_sub_u32 s92, s92, 1
    s_cbranch_scc0 L28
L27:
    v_mov_b32 v24, s48
    v_mov_b32 v25, s49
    s_waitcnt vmcnt(6)
    s_mov_b64 exec, 0xff
    buffer_store_dwordx2 v[24:25], v4, s[40:43], s6 offen sc1
    s_mov_b64 exec, -1
    s_lshl3_add_u32 s6, s44, s45
    s_lshl_b32 s6, s6, 7
    s_add_u32 s6, s6, 0x4a0000
    s_load_dword s59, s[40:41], s6 glc
    s_add_u32 s7, s6, 512
    s_load_dword s59, s[40:41], s7 glc
    s_add_u32 s5, s4, 197376
    buffer_load_dwordx3 v[120:122], v249, s[12:15], s5 offen
    v_cos_f32 v224, v216
    v_cos_f32 v225, v217
    v_cos_f32 v226, v218
    v_cos_f32 v227, v219
    v_sin_f32 v228, v212
    v_sin_f32 v229, v213
    v_sin_f32 v230, v214
    v_sin_f32 v231, v215
    v_sin_f32 v232, v216
    v_sin_f32 v233, v217
    buffer_load_dwordx3 v[124:126], v249, s[16:19], s5 offen
    v_sin_f32 v234, v218
    v_sin_f32 v235, v219
    v_cvt_pk_bf16_f32 v180, v220, v228
    v_cvt_pk_bf16_f32 v184, -v228, v220
    v_cvt_pk_bf16_f32 v188, v224, -v232
    v_cvt_pk_bf16_f32 v192, v232, v224
    v_cvt_pk_bf16_f32 v181, v221, v229
    v_cvt_pk_bf16_f32 v185, -v229, v221
    v_cvt_pk_bf16_f32 v189, v225, -v233
    s_add_u32 s5, s4, 4112
    buffer_load_dwordx3 v[148:150], v249, s[12:15], s5 offen
    v_cvt_pk_bf16_f32 v193, v233, v225
    v_cvt_pk_bf16_f32 v182, v222, v230
    v_cvt_pk_bf16_f32 v186, -v230, v222
    v_cvt_pk_bf16_f32 v190, v226, -v234
    v_cvt_pk_bf16_f32 v194, v234, v226
    v_cvt_pk_bf16_f32 v183, v223, v231
    v_cvt_pk_bf16_f32 v187, -v231, v223
    v_cvt_pk_bf16_f32 v191, v227, -v235
    v_cvt_pk_bf16_f32 v195, v235, v227
    buffer_load_dwordx3 v[152:154], v249, s[16:19], s5 offen
    v_add_u32 v5, 1, v5
    v_add_u32 v212, 0, v6
    v_add_u32 v216, 1, v7
    v_add_u32 v213, 1, v6
    v_add_u32 v217, 17, v7
    v_add_u32 v214, 2, v6
    v_add_u32 v218, 33, v7
    v_add_u32 v215, 3, v6
    v_add_u32 v219, 49, v7
    v_mul_u32_u24 v212, v212, v5
    s_add_u32 s5, s4, 69904
    buffer_load_dwordx3 v[156:158], v249, s[12:15], s5 offen
    v_mul_u32_u24 v216, v216, v2
    v_mul_u32_u24 v213, v213, v5
    v_mul_u32_u24 v217, v217, v2
    v_mul_u32_u24 v214, v214, v5
    v_mul_u32_u24 v218, v218, v2
    v_mul_u32_u24 v215, v215, v5
    v_mul_u32_u24 v219, v219, v2
    v_cvt_f32_ubyte0 v212, v212
    v_cvt_f32_ubyte0 v213, v213
    buffer_load_dwordx3 v[160:162], v249, s[16:19], s5 offen
    v_cvt_f32_ubyte0 v214, v214
    v_cvt_f32_ubyte0 v215, v215
    v_cvt_f32_ubyte0 v216, v216
    v_cvt_f32_ubyte0 v217, v217
    v_cvt_f32_ubyte0 v218, v218
    v_cvt_f32_ubyte0 v219, v219
    v_mul_f32 v212, 0x3b800000, v212
    v_mul_f32 v213, 0x3b800000, v213
    v_mul_f32 v214, 0x3b800000, v214
    s_add_u32 s5, s4, 135696
    buffer_load_dwordx3 v[164:166], v249, s[12:15], s5 offen
    v_mul_f32 v215, 0x3b800000, v215
    v_mul_f32 v216, 0x3b800000, v216
    v_mul_f32 v217, 0x3b800000, v217
    v_mul_f32 v218, 0x3b800000, v218
    v_mul_f32 v219, 0x3b800000, v219
    v_cos_f32 v220, v212
    v_cos_f32 v221, v213
    v_cos_f32 v222, v214
    v_cos_f32 v223, v215
    v_cos_f32 v224, v216
    buffer_load_dwordx3 v[168:170], v249, s[16:19], s5 offen
    v_cos_f32 v225, v217
    v_cos_f32 v226, v218
    v_cos_f32 v227, v219
    v_sin_f32 v228, v212
    v_sin_f32 v229, v213
    v_sin_f32 v230, v214
    v_sin_f32 v231, v215
    v_sin_f32 v232, v216
    v_sin_f32 v233, v217
    s_add_u32 s5, s4, 201488
    buffer_load_dwordx3 v[172:174], v249, s[12:15], s5 offen
    v_sin_f32 v234, v218
    v_sin_f32 v235, v219
    v_cvt_pk_bf16_f32 v196, v220, v228
    v_cvt_pk_bf16_f32 v200, -v228, v220
    v_cvt_pk_bf16_f32 v204, v224, -v232
    v_cvt_pk_bf16_f32 v208, v232, v224
    v_cvt_pk_bf16_f32 v197, v221, v229
    v_cvt_pk_bf16_f32 v201, -v229, v221
    v_cvt_pk_bf16_f32 v205, v225, -v233
    buffer_load_dwordx3 v[176:178], v249, s[16:19], s5 offen
    v_cvt_pk_bf16_f32 v209, v233, v225
    v_cvt_pk_bf16_f32 v198, v222, v230
    v_cvt_pk_bf16_f32 v202, -v230, v222
    v_cvt_pk_bf16_f32 v206, v226, -v234
    v_cvt_pk_bf16_f32 v210, v234, v226
    v_cvt_pk_bf16_f32 v199, v223, v231
    v_cvt_pk_bf16_f32 v203, -v231, v223
    v_cvt_pk_bf16_f32 v207, v227, -v235
    v_cvt_pk_bf16_f32 v211, v235, v227
LbD:
    s_nop 1
    s_mov_b32 s4, 532480
    v_mul_lo_u32 v244, v3, s4
    v_lshl_add_u32 v244, v2, 4, v244
    s_mul_i32 s4, s3, 16640
    s_lshl_b32 s5, s47, 8
    s_add_u32 s93, s4, s5
    s_and_b32 s4, s3, 1
    s_lshl_b32 s4, s4, 9
    s_lshr_b32 s5, s3, 1
    s_lshl_b32 s5, s5, 7
    s_add_u32 s4, s4, s5
    v_lshlrev_b32 v5, 14, v3
    v_lshl_add_u32 v5, v2, 3, v5
    v_add_u32 v245, s4, v5
    v_add_u32 v246, 65536, v245
    v_lshlrev_b32 v250, 3, v1
    s_lshl_b32 s4, s3, 13
    v_add_u32 v247, s4, v250
    v_add_u32 v248, 65536, v247
    s_lshl_b32 s4, s47, 11
    s_lshl_b32 s5, s3, 8
    s_add_u32 s4, s4, s5
    s_add_u32 s95, s4, 0x488000
    s_bfe_u32 s5, s47, 0x20002
    s_lshl_b32 s5, s5, 7
    s_add_u32 s4, s5, 0x500000
    s_lshr_b32 s5, s47, 4
    s_lshl_b32 s5, s5, 3
    s_add_u32 s100, s4, s5
    s_lshl_b32 s5, s5, 2
    s_add_u32 s4, s4, s5
    s_lshl_b32 s5, s3, 9
    s_add_u32 s4, s4, s5
    s_and_b32 s5, s47, 3
    s_lshl_b32 s6, s5, 3
    s_add_u32 s94, s4, s6
    v_lshlrev_b32 v252, 9, v1
    v_lshlrev_b32 v253, 12, v1
    s_xor_b32 s6, s3, 0
    s_or_b32 s5, s5, s6
    s_cmp_eq_u32 s5, 0
    s_cselect_b32 s98, -1, 0
    s_bitcmp1_b32 s47, 2
    s_cselect_b32 s4, 0x02020000, 0
    s_add_u32 s5, s4, 0x03020c0c
    s_add_u32 s4, s4, 0x01000c0c
    s_waitcnt vmcnt(0)
    v_perm_b32 v32, v97, v96, s4
    v_perm_b32 v40, v97, v96, s5
    v_perm_b32 v48, v98, v97, s4
    v_perm_b32 v56, v98, v97, s5
    v_perm_b32 v36, v101, v100, s4
    v_perm_b32 v44, v101, v100, s5
    v_perm_b32 v52, v102, v101, s4
    v_perm_b32 v60, v102, v101, s5
    v_perm_b32 v33, v105, v104, s4
    v_perm_b32 v41, v105, v104, s5
    v_perm_b32 v49, v106, v105, s4
    v_perm_b32 v57, v106, v105, s5
    v_perm_b32 v37, v109, v108, s4
    v_perm_b32 v45, v109, v108, s5
    v_perm_b32 v53, v110, v109, s4
    v_perm_b32 v61, v110, v109, s5
    v_perm_b32 v34, v113, v112, s4
    v_perm_b32 v42, v113, v112, s5
    v_perm_b32 v50, v114, v113, s4
    v_perm_b32 v58, v114, v113, s5
    v_perm_b32 v38, v117, v116, s4
    v_perm_b32 v46, v117, v116, s5
    v_perm_b32 v54, v118, v117, s4
    v_perm_b32 v62, v118, v117, s5
    v_perm_b32 v35, v121, v120, s4
    v_perm_b32 v43, v121, v120, s5
    v_perm_b32 v51, v122, v121, s4
    v_perm_b32 v59, v122, v121, s5
    v_perm_b32 v39, v125, v124, s4
    v_perm_b32 v47, v125, v124, s5
    v_perm_b32 v55, v126, v125, s4
    v_perm_b32 v63, v126, v125, s5
    v_perm_b32 v64, v149, v148, s4
    v_perm_b32 v72, v149, v148, s5
    v_perm_b32 v80, v150, v149, s4
    v_perm_b32 v88, v150, v149, s5
    v_perm_b32 v68, v153, v152, s4
    v_perm_b32 v76, v153, v152, s5
    v_perm_b32 v84, v154, v153, s4
    v_perm_b32 v92, v154, v153, s5
    v_perm_b32 v65, v157, v156, s4
    v_perm_b32 v73, v157, v156, s5
    v_perm_b32 v81, v158, v157, s4
    v_perm_b32 v89, v158, v157, s5
    v_perm_b32 v69, v161, v160, s4
    v_perm_b32 v77, v161, v160, s5
    v_perm_b32 v85, v162, v161, s4
    v_perm_b32 v93, v162, v161, s5
    v_perm_b32 v66, v165, v164, s4
    v_perm_b32 v74, v165, v164, s5
    v_perm_b32 v82, v166, v165, s4
    v_perm_b32 v90, v166, v165, s5
    v_perm_b32 v70, v169, v168, s4
    v_perm_b32 v78, v169, v168, s5
    v_perm_b32 v86, v170, v169, s4
    v_perm_b32 v94, v170, v169, s5
    v_perm_b32 v67, v173, v172, s4
    v_perm_b32 v75, v173, v172, s5
    v_perm_b32 v83, v174, v173, s4
    v_perm_b32 v91, v174, v173, s5
    v_perm_b32 v71, v177, v176, s4
    v_perm_b32 v79, v177, v176, s5
    v_perm_b32 v87, v178, v177, s4
    v_perm_b32 v95, v178, v177, s5
    s_mov_b64 s[20:21], s[12:13]
    s_mov_b64 s[24:25], s[16:17]
    s_mov_b64 s[22:23], s[14:15]
    s_mov_b64 s[26:27], s[18:19]
    s_add_u32 s8, s93, 0
    s_add_u32 s10, s93, 133120
    s_add_u32 s12, s93, 266240
    s_add_u32 s14, s93, 399360
    s_add_u32 s9, s93, 8320
    s_add_u32 s11, s93, 141440
    s_add_u32 s13, s93, 274560
    s_add_u32 s15, s93, 407680
    s_setprio 3
    s_mov_b32 s92, 400000
    s_mov_b32 s16, 0
L29:
    s_mov_b32 exec_hi, 0
    buffer_load_dwordx2 v[128:129], v250, s[40:43], s95 offen sc1
    s_waitcnt vmcnt(0)
    v_cmp_eq_u64 vcc, s[48:49], v[128:129]
    s_mov_b32 exec_hi, -1
    s_lshr_b32 s4, vcc_lo, 16
    s_and_b32 s4, s4, vcc_lo
    s_lshr_b32 s5, s4, 8
    s_and_b32 s4, s4, s5
    s_andn2_b32 s5, s4, s16
    s_cbranch_scc0 Lun
    s_mov_b32 s16, s4
    s_bitcmp1_b32 s5, 0
    s_cbranch_scc0 L30
    buffer_load_dwordx4 v[96:99], v244, s[40:43], s8 offen sc1
L30:
    s_bitcmp1_b32 s5, 2
    s_cbranch_scc0 L31
    buffer_load_dwordx4 v[100:103], v244, s[40:43], s10 offen sc1
L31:
    s_bitcmp1_b32 s5, 4
    s_cbranch_scc0 L32
    buffer_load_dwordx4 v[104:107], v244, s[40:43], s12 offen sc1
L32:
    s_bitcmp1_b32 s5, 6
    s_cbranch_scc0 L33
    buffer_load_dwordx4 v[108:111], v244, s[40:43], s14 offen sc1
L33:
    s_bitcmp1_b32 s5, 1
    s_cbranch_scc0 L34
    buffer_load_dwordx4 v[112:115], v244, s[40:43], s9 offen sc1
L34:
    s_bitcmp1_b32 s5, 3
    s_cbranch_scc0 L35
    buffer_load_dwordx4 v[116:119], v244, s[40:43], s11 offen sc1
L35:
    s_bitcmp1_b32 s5, 5
    s_cbranch_scc0 L36
    buffer_load_dwordx4 v[120:123], v244, s[40:43], s13 offen sc1
L36:
    s_bitcmp1_b32 s5, 7
    s_cbranch_scc0 L37
    buffer_load_dwordx4 v[124:127], v244, s[40:43], s15 offen sc1
L37:
    s_cmp_eq_u32 s16, 0xff
    s_cbranch_scc1 Lud
Lun:
    s_sleep 1
    s_sub_u32 s92, s92, 1
    s_cbranch_scc0 L29
Lud:
    s_waitcnt vmcnt(0)
Lbj:
    v_mov_b32 v212, v96
    v_mov_b32 v216, v97
    v_mov_b32 v220, v98
    v_mov_b32 v224, v99
    v_mov_b32 v213, v100
    v_mov_b32 v217, v101
    v_mov_b32 v221, v102
    v_mov_b32 v225, v103
    v_mov_b32 v214, v104
    v_mov_b32 v218, v105
    v_mov_b32 v222, v106
    v_mov_b32 v226, v107
    v_mov_b32 v215, v108
    v_mov_b32 v219, v109
    v_mov_b32 v223, v110
    v_mov_b32 v227, v111
    v_mfma_f32_16x16x32_bf16 v[148:151], v[8:11], v[212:215], 0
    v_mfma_f32_16x16x32_bf16 v[152:155], v[12:15], v[212:215], 0
    v_mfma_f32_16x16x32_bf16 v[156:159], v[8:11], v[216:219], 0
    v_mfma_f32_16x16x32_bf16 v[160:163], v[12:15], v[216:219], 0
    v_mfma_f32_16x16x32_bf16 v[164:167], v[8:11], v[220:223], 0
    v_mfma_f32_16x16x32_bf16 v[168:171], v[12:15], v[220:223], 0
    v_mfma_f32_16x16x32_bf16 v[172:175], v[8:11], v[224:227], 0
    v_mfma_f32_16x16x32_bf16 v[176:179], v[12:15], v[224:227], 0
    v_mov_b32 v228, v112
    v_mov_b32 v232, v113
    v_mov_b32 v236, v114
    v_mov_b32 v240, v115
    v_mov_b32 v229, v116
    v_mov_b32 v233, v117
    v_mov_b32 v237, v118
    v_mov_b32 v241, v119
    v_mov_b32 v230, v120
    v_mov_b32 v234, v121
    v_mov_b32 v238, v122
    v_mov_b32 v242, v123
    v_mov_b32 v231, v124
    v_mov_b32 v235, v125
    v_mov_b32 v239, v126
    v_mov_b32 v243, v127
    v_cvt_pk_bf16_f32 v96, v148, v152
    v_cvt_pk_bf16_f32 v98, v149, v153
    v_cvt_pk_bf16_f32 v100, v150, v154
    v_cvt_pk_bf16_f32 v102, v151, v155
    v_mfma_f32_16x16x32_bf16 v[148:151], v[8:11], v[228:231], 0
    v_mfma_f32_16x16x32_bf16 v[152:155], v[12:15], v[228:231], 0
    v_cvt_pk_bf16_f32 v104, v156, v160
    v_cvt_pk_bf16_f32 v106, v157, v161
    v_cvt_pk_bf16_f32 v108, v158, v162
    v_cvt_pk_bf16_f32 v110, v159, v163
    v_mfma_f32_16x16x32_bf16 v[156:159], v[8:11], v[232:235], 0
    v_mfma_f32_16x16x32_bf16 v[160:163], v[12:15], v[232:235], 0
    v_cvt_pk_bf16_f32 v112, v164, v168
    v_cvt_pk_bf16_f32 v114, v165, v169
    v_cvt_pk_bf16_f32 v116, v166, v170
    v_cvt_pk_bf16_f32 v118, v167, v171
    v_mfma_f32_16x16x32_bf16 v[164:167], v[8:11], v[236:239], 0
    v_mfma_f32_16x16x32_bf16 v[168:171], v[12:15], v[236:239], 0
    v_cvt_pk_bf16_f32 v120, v172, v176
    v_cvt_pk_bf16_f32 v122, v173, v177
    v_cvt_pk_bf16_f32 v124, v174, v178
    v_cvt_pk_bf16_f32 v126, v175, v179
    v_mfma_f32_16x16x32_bf16 v[172:175], v[8:11], v[240:243], 0
    v_mfma_f32_16x16x32_bf16 v[176:179], v[12:15], v[240:243], 0
    v_cvt_pk_bf16_f32 v97, v148, v152
    ds_write_b64 v245, v[96:97] offset:0
    v_cvt_pk_bf16_f32 v99, v149, v153
    ds_write_b64 v245, v[98:99] offset:4096
    v_cvt_pk_bf16_f32 v101, v150, v154
    ds_write_b64 v245, v[100:101] offset:8192
    v_cvt_pk_bf16_f32 v103, v151, v155
    ds_write_b64 v245, v[102:103] offset:12288
    v_cvt_pk_bf16_f32 v105, v156, v160
    ds_write_b64 v245, v[104:105] offset:1024
    v_cvt_pk_bf16_f32 v107, v157, v161
    ds_write_b64 v245, v[106:107] offset:5120
    v_cvt_pk_bf16_f32 v109, v158, v162
    ds_write_b64 v245, v[108:109] offset:9216
    v_cvt_pk_bf16_f32 v111, v159, v163
    ds_write_b64 v245, v[110:111] offset:13312
    v_cvt_pk_bf16_f32 v113, v164, v168
    ds_write_b64 v245, v[112:113] offset:2048
    v_cvt_pk_bf16_f32 v115, v165, v169
    ds_write_b64 v245, v[114:115] offset:6144
    v_cvt_pk_bf16_f32 v117, v166, v170
    ds_write_b64 v245, v[116:117] offset:10240
    v_cvt_pk_bf16_f32 v119, v167, v171
    ds_write_b64 v245, v[118:119] offset:14336
    v_cvt_pk_bf16_f32 v121, v172, v176
    ds_write_b64 v245, v[120:121] offset:3072
    v_cvt_pk_bf16_f32 v123, v173, v177
    ds_write_b64 v245, v[122:123] offset:7168
    v_cvt_pk_bf16_f32 v125, v174, v178
    ds_write_b64 v245, v[124:125] offset:11264
    v_cvt_pk_bf16_f32 v127, v175, v179
    ds_write_b64 v245, v[126:127] offset:15360
    s_waitcnt lgkmcnt(0)
    s_barrier
    ds_read_b64 v[212:213], v247 offset:0
    ds_read_b64 v[214:215], v247 offset:512
    ds_read_b64 v[216:217], v247 offset:4096
    ds_read_b64 v[218:219], v247 offset:4608
    ds_read_b64 v[220:221], v247 offset:1024
    ds_read_b64 v[222:223], v247 offset:1536
    ds_read_b64 v[224:225], v247 offset:5120
    ds_read_b64 v[226:227], v247 offset:5632
    ds_read_b64 v[228:229], v247 offset:2048
    ds_read_b64 v[230:231], v247 offset:2560
    ds_read_b64 v[232:233], v247 offset:6144
    ds_read_b64 v[234:235], v247 offset:6656
    ds_read_b64 v[236:237], v247 offset:3072
    ds_read_b64 v[238:239], v247 offset:3584
    ds_read_b64 v[240:241], v247 offset:7168
    ds_read_b64 v[242:243], v247 offset:7680
    s_waitcnt lgkmcnt(14)
    v_mfma_f32_16x16x32_bf16 v[148:151], v[180:183], v[212:215], 0
    v_mfma_f32_16x16x32_bf16 v[152:155], v[184:187], v[212:215], 0
    s_waitcnt lgkmcnt(12)
    v_mfma_f32_16x16x32_bf16 v[156:159], v[196:199], v[216:219], 0
    v_mfma_f32_16x16x32_bf16 v[160:163], v[200:203], v[216:219], 0
    s_waitcnt lgkmcnt(10)
    v_mfma_f32_16x16x32_bf16 v[164:167], v[180:183], v[220:223], 0
    v_mfma_f32_16x16x32_bf16 v[168:171], v[184:187], v[220:223], 0
    s_waitcnt lgkmcnt(8)
    v_mfma_f32_16x16x32_bf16 v[172:175], v[196:199], v[224:227], 0
    v_mfma_f32_16x16x32_bf16 v[176:179], v[200:203], v[224:227], 0
    s_waitcnt lgkmcnt(6)
    v_mfma_f32_16x16x32_bf16 v[96:99], v[180:183], v[228:231], 0
    v_mfma_f32_16x16x32_bf16 v[100:103], v[184:187], v[228:231], 0
    s_waitcnt lgkmcnt(4)
    v_mfma_f32_16x16x32_bf16 v[104:107], v[196:199], v[232:235], 0
    v_mfma_f32_16x16x32_bf16 v[108:111], v[200:203], v[232:235], 0
    s_waitcnt lgkmcnt(2)
    v_mfma_f32_16x16x32_bf16 v[112:115], v[180:183], v[236:239], 0
    v_mfma_f32_16x16x32_bf16 v[116:119], v[184:187], v[236:239], 0
    s_waitcnt lgkmcnt(0)
    v_mfma_f32_16x16x32_bf16 v[120:123], v[196:199], v[240:243], 0
    v_mfma_f32_16x16x32_bf16 v[124:127], v[200:203], v[240:243], 0
    s_cmp_eq_u32 s98, 0
    s_cbranch_scc1 Lnw
    s_lshl_b32 s6, s47, 8
    s_add_u32 s7, s6, 0x480000
    buffer_load_dwordx4 v[144:147], v30, s[40:43], s7 offen sc1
    v_lshl_add_u32 v4, v3, 6, v2
    s_movk_i32 s5, 4112
    v_mul_lo_u32 v4, v4, s5
    s_lshr_b32 s6, s47, 2
    s_mul_i32 s6, s6, 514
    buffer_load_ushort v180, v4, s[20:23], s6 offen offset:512
    buffer_load_ushort v184, v4, s[24:27], s6 offen offset:512
    s_add_u32 s6, s6, 65792
    buffer_load_ushort v181, v4, s[20:23], s6 offen offset:512
    buffer_load_ushort v185, v4, s[24:27], s6 offen offset:512
    s_add_u32 s6, s6, 65792
    buffer_load_ushort v182, v4, s[20:23], s6 offen offset:512
    buffer_load_ushort v186, v4, s[24:27], s6 offen offset:512
    s_add_u32 s6, s6, 65792
    buffer_load_ushort v183, v4, s[20:23], s6 offen offset:512
    buffer_load_ushort v187, v4, s[24:27], s6 offen offset:512
Lnw:
    v_xor_b32 v136, 0x80000000, v8
    v_xor_b32 v140, 0x8000, v12
    v_xor_b32 v137, 0x80000000, v9
    v_xor_b32 v141, 0x8000, v13
    v_xor_b32 v138, 0x80000000, v10
    v_xor_b32 v142, 0x8000, v14
    v_xor_b32 v139, 0x80000000, v11
    v_xor_b32 v143, 0x8000, v15
    v_mul_f32 v128, v152, v36
    v_mul_f32 v129, v153, v37
    v_mul_f32 v130, v154, v38
    v_mul_f32 v131, v155, v39
    v_mul_f32 v36, v148, v36
    v_mul_f32 v37, v149, v37
    v_mul_f32 v38, v150, v38
    v_mul_f32 v39, v151, v39
    v_fma_f32 v148, v148, v32, -v128
    v_fma_f32 v149, v149, v33, -v129
    v_fma_f32 v150, v150, v34, -v130
    v_fma_f32 v151, v151, v35, -v131
    v_fmac_f32 v36, v152, v32
    v_fmac_f32 v37, v153, v33
    v_fmac_f32 v38, v154, v34
    v_fmac_f32 v39, v155, v35
    v_mul_f32 v132, v160, v68
    v_mul_f32 v133, v161, v69
    v_mul_f32 v134, v162, v70
    v_mul_f32 v135, v163, v71
    v_mul_f32 v68, v156, v68
    v_mul_f32 v69, v157, v69
    v_mul_f32 v70, v158, v70
    v_mul_f32 v71, v159, v71
    v_fma_f32 v156, v156, v64, -v132
    v_fma_f32 v157, v157, v65, -v133
    v_fma_f32 v158, v158, v66, -v134
    v_fma_f32 v159, v159, v67, -v135
    v_fmac_f32 v68, v160, v64
    v_fmac_f32 v69, v161, v65
    v_fmac_f32 v70, v162, v66
    v_fmac_f32 v71, v163, v67
    v_mul_f32 v128, v168, v44
    v_mul_f32 v129, v169, v45
    v_mul_f32 v130, v170, v46
    v_mul_f32 v131, v171, v47
    v_mul_f32 v44, v164, v44
    v_mul_f32 v45, v165, v45
    v_mul_f32 v46, v166, v46
    v_mul_f32 v47, v167, v47
    v_fma_f32 v164, v164, v40, -v128
    v_fma_f32 v165, v165, v41, -v129
    v_fma_f32 v166, v166, v42, -v130
    v_fma_f32 v167, v167, v43, -v131
    v_fmac_f32 v44, v168, v40
    v_fmac_f32 v45, v169, v41
    v_fmac_f32 v46, v170, v42
    v_fmac_f32 v47, v171, v43
    v_mul_f32 v132, v176, v76
    v_mul_f32 v133, v177, v77
    v_mul_f32 v134, v178, v78
    v_mul_f32 v135, v179, v79
    v_mul_f32 v76, v172, v76
    v_mul_f32 v77, v173, v77
    v_mul_f32 v78, v174, v78
    v_mul_f32 v79, v175, v79
    v_fma_f32 v172, v172, v72, -v132
    v_fma_f32 v173, v173, v73, -v133
    v_fma_f32 v174, v174, v74, -v134
    v_fma_f32 v175, v175, v75, -v135
    v_fmac_f32 v76, v176, v72
    v_fmac_f32 v77, v177, v73
    v_fmac_f32 v78, v178, v74
    v_fmac_f32 v79, v179, v75
    v_mul_f32 v128, v100, v52
    v_mul_f32 v129, v101, v53
    v_mul_f32 v130, v102, v54
    v_mul_f32 v131, v103, v55
    v_mul_f32 v52, v96, v52
    v_mul_f32 v53, v97, v53
    v_mul_f32 v54, v98, v54
    v_mul_f32 v55, v99, v55
    v_fma_f32 v96, v96, v48, -v128
    v_fma_f32 v97, v97, v49, -v129
    v_fma_f32 v98, v98, v50, -v130
    v_fma_f32 v99, v99, v51, -v131
    v_fmac_f32 v52, v100, v48
    v_fmac_f32 v53, v101, v49
    v_fmac_f32 v54, v102, v50
    v_fmac_f32 v55, v103, v51
    v_mul_f32 v132, v108, v84
    v_mul_f32 v133, v109, v85
    v_mul_f32 v134, v110, v86
    v_mul_f32 v135, v111, v87
    v_mul_f32 v84, v104, v84
    v_mul_f32 v85, v105, v85
    v_mul_f32 v86, v106, v86
    v_mul_f32 v87, v107, v87
    v_fma_f32 v104, v104, v80, -v132
    v_fma_f32 v105, v105, v81, -v133
    v_fma_f32 v106, v106, v82, -v134
    v_fma_f32 v107, v107, v83, -v135
    v_fmac_f32 v84, v108, v80
    v_fmac_f32 v85, v109, v81
    v_fmac_f32 v86, v110, v82
    v_fmac_f32 v87, v111, v83
    v_mul_f32 v128, v116, v60
    v_mul_f32 v129, v117, v61
    v_mul_f32 v130, v118, v62
    v_mul_f32 v131, v119, v63
    v_mul_f32 v60, v112, v60
    v_mul_f32 v61, v113, v61
    v_mul_f32 v62, v114, v62
    v_mul_f32 v63, v115, v63
    v_fma_f32 v112, v112, v56, -v128
    v_fma_f32 v113, v113, v57, -v129
    v_fma_f32 v114, v114, v58, -v130
    v_fma_f32 v115, v115, v59, -v131
    v_fmac_f32 v60, v116, v56
    v_fmac_f32 v61, v117, v57
    v_fmac_f32 v62, v118, v58
    v_fmac_f32 v63, v119, v59
    v_mul_f32 v132, v124, v92
    v_mul_f32 v133, v125, v93
    v_mul_f32 v134, v126, v94
    v_mul_f32 v135, v127, v95
    v_mul_f32 v92, v120, v92
    v_mul_f32 v93, v121, v93
    v_mul_f32 v94, v122, v94
    v_mul_f32 v95, v123, v95
    v_fma_f32 v120, v120, v88, -v132
    v_fma_f32 v121, v121, v89, -v133
    v_fma_f32 v122, v122, v90, -v134
    v_fma_f32 v123, v123, v91, -v135
    v_fmac_f32 v92, v124, v88
    v_fmac_f32 v93, v125, v89
    v_fmac_f32 v94, v126, v90
    v_fmac_f32 v95, v127, v91
    v_cvt_pk_bf16_f32 v212, v148, v36
    v_cvt_pk_bf16_f32 v213, v149, v37
    v_cvt_pk_bf16_f32 v214, v150, v38
    v_cvt_pk_bf16_f32 v215, v151, v39
    s_nop 1
    v_mfma_f32_16x16x32_bf16 v[148:151], v[188:191], v[212:215], 0
    v_mfma_f32_16x16x32_bf16 v[152:155], v[192:195], v[212:215], 0
    v_cvt_pk_bf16_f32 v216, v156, v68
    v_cvt_pk_bf16_f32 v217, v157, v69
    v_cvt_pk_bf16_f32 v218, v158, v70
    v_cvt_pk_bf16_f32 v219, v159, v71
    s_nop 1
    v_mfma_f32_16x16x32_bf16 v[156:159], v[204:207], v[216:219], 0
    v_mfma_f32_16x16x32_bf16 v[160:163], v[208:211], v[216:219], 0
    v_cvt_pk_bf16_f32 v220, v164, v44
    v_cvt_pk_bf16_f32 v221, v165, v45
    v_cvt_pk_bf16_f32 v222, v166, v46
    v_cvt_pk_bf16_f32 v223, v167, v47
    v_cvt_pk_bf16_f32 v32, v148, v152
    v_cvt_pk_bf16_f32 v34, v149, v153
    v_cvt_pk_bf16_f32 v64, v150, v154
    v_cvt_pk_bf16_f32 v66, v151, v155
    v_mfma_f32_16x16x32_bf16 v[164:167], v[188:191], v[220:223], 0
    v_mfma_f32_16x16x32_bf16 v[168:171], v[192:195], v[220:223], 0
    v_cvt_pk_bf16_f32 v224, v172, v76
    v_cvt_pk_bf16_f32 v225, v173, v77
    v_cvt_pk_bf16_f32 v226, v174, v78
    v_cvt_pk_bf16_f32 v227, v175, v79
    v_cvt_pk_bf16_f32 v33, v156, v160
    ds_write_b64 v246, v[32:33] offset:0
    v_cvt_pk_bf16_f32 v35, v157, v161
    ds_write_b64 v246, v[34:35] offset:4096
    v_cvt_pk_bf16_f32 v65, v158, v162
    ds_write_b64 v246, v[64:65] offset:8192
    v_cvt_pk_bf16_f32 v67, v159, v163
    ds_write_b64 v246, v[66:67] offset:12288
    v_mfma_f32_16x16x32_bf16 v[172:175], v[204:207], v[224:227], 0
    v_mfma_f32_16x16x32_bf16 v[176:179], v[208:211], v[224:227], 0
    v_cvt_pk_bf16_f32 v228, v96, v52
    v_cvt_pk_bf16_f32 v229, v97, v53
    v_cvt_pk_bf16_f32 v230, v98, v54
    v_cvt_pk_bf16_f32 v231, v99, v55
    v_cvt_pk_bf16_f32 v40, v164, v168
    v_cvt_pk_bf16_f32 v42, v165, v169
    v_cvt_pk_bf16_f32 v72, v166, v170
    v_cvt_pk_bf16_f32 v74, v167, v171
    v_mfma_f32_16x16x32_bf16 v[96:99], v[188:191], v[228:231], 0
    v_mfma_f32_16x16x32_bf16 v[100:103], v[192:195], v[228:231], 0
    v_cvt_pk_bf16_f32 v232, v104, v84
    v_cvt_pk_bf16_f32 v233, v105, v85
    v_cvt_pk_bf16_f32 v234, v106, v86
    v_cvt_pk_bf16_f32 v235, v107, v87
    v_cvt_pk_bf16_f32 v41, v172, v176
    ds_write_b64 v246, v[40:41] offset:1024
    v_cvt_pk_bf16_f32 v43, v173, v177
    ds_write_b64 v246, v[42:43] offset:5120
    v_cvt_pk_bf16_f32 v73, v174, v178
    ds_write_b64 v246, v[72:73] offset:9216
    v_cvt_pk_bf16_f32 v75, v175, v179
    ds_write_b64 v246, v[74:75] offset:13312
    v_mfma_f32_16x16x32_bf16 v[104:107], v[204:207], v[232:235], 0
    v_mfma_f32_16x16x32_bf16 v[108:111], v[208:211], v[232:235], 0
    v_cvt_pk_bf16_f32 v236, v112, v60
    v_cvt_pk_bf16_f32 v237, v113, v61
    v_cvt_pk_bf16_f32 v238, v114, v62
    v_cvt_pk_bf16_f32 v239, v115, v63
    v_cvt_pk_bf16_f32 v48, v96, v100
    v_cvt_pk_bf16_f32 v50, v97, v101
    v_cvt_pk_bf16_f32 v80, v98, v102
    v_cvt_pk_bf16_f32 v82, v99, v103
    v_mfma_f32_16x16x32_bf16 v[112:115], v[188:191], v[236:239], 0
    v_mfma_f32_16x16x32_bf16 v[116:119], v[192:195], v[236:239], 0
    v_cvt_pk_bf16_f32 v240, v120, v92
    v_cvt_pk_bf16_f32 v241, v121, v93
    v_cvt_pk_bf16_f32 v242, v122, v94
    v_cvt_pk_bf16_f32 v243, v123, v95
    v_cvt_pk_bf16_f32 v49, v104, v108
    ds_write_b64 v246, v[48:49] offset:2048
    v_cvt_pk_bf16_f32 v51, v105, v109
    ds_write_b64 v246, v[50:51] offset:6144
    v_cvt_pk_bf16_f32 v81, v106, v110
    ds_write_b64 v246, v[80:81] offset:10240
    v_cvt_pk_bf16_f32 v83, v107, v111
    ds_write_b64 v246, v[82:83] offset:14336
    v_mfma_f32_16x16x32_bf16 v[120:123], v[204:207], v[240:243], 0
    v_mfma_f32_16x16x32_bf16 v[124:127], v[208:211], v[240:243], 0
    v_cvt_pk_bf16_f32 v56, v112, v116
    v_cvt_pk_bf16_f32 v58, v113, v117
    v_cvt_pk_bf16_f32 v88, v114, v118
    v_cvt_pk_bf16_f32 v90, v115, v119
    s_nop 3
    v_cvt_pk_bf16_f32 v57, v120, v124
    ds_write_b64 v246, v[56:57] offset:3072
    v_cvt_pk_bf16_f32 v59, v121, v125
    ds_write_b64 v246, v[58:59] offset:7168
    v_cvt_pk_bf16_f32 v89, v122, v126
    ds_write_b64 v246, v[88:89] offset:11264
    v_cvt_pk_bf16_f32 v91, v123, v127
    ds_write_b64 v246, v[90:91] offset:15360
    s_waitcnt lgkmcnt(0)
    s_barrier
    ds_read_b64 v[212:213], v248 offset:0
    ds_read_b64 v[214:215], v248 offset:512
    ds_read_b64 v[216:217], v248 offset:1024
    ds_read_b64 v[218:219], v248 offset:1536
    ds_read_b64 v[220:221], v248 offset:2048
    ds_read_b64 v[222:223], v248 offset:2560
    ds_read_b64 v[224:225], v248 offset:3072
    ds_read_b64 v[226:227], v248 offset:3584
    ds_read_b64 v[228:229], v248 offset:4096
    ds_read_b64 v[230:231], v248 offset:4608
    ds_read_b64 v[232:233], v248 offset:5120
    ds_read_b64 v[234:235], v248 offset:5632
    ds_read_b64 v[236:237], v248 offset:6144
    ds_read_b64 v[238:239], v248 offset:6656
    ds_read_b64 v[240:241], v248 offset:7168
    ds_read_b64 v[242:243], v248 offset:7680
    s_add_u32 s93, s93, 0x240000
    s_waitcnt lgkmcnt(14)
    v_mfma_f32_16x16x32_bf16 v[148:151], v[136:139], v[212:215], 0
    v_mfma_f32_16x16x32_bf16 v[152:155], v[140:143], v[212:215], 0
    s_waitcnt lgkmcnt(12)
    v_mfma_f32_16x16x32_bf16 v[156:159], v[136:139], v[216:219], 0
    v_mfma_f32_16x16x32_bf16 v[160:163], v[140:143], v[216:219], 0
    s_waitcnt lgkmcnt(10)
    v_mfma_f32_16x16x32_bf16 v[164:167], v[136:139], v[220:223], 0
    v_mfma_f32_16x16x32_bf16 v[168:171], v[140:143], v[220:223], 0
    s_waitcnt lgkmcnt(8)
    v_mfma_f32_16x16x32_bf16 v[172:175], v[136:139], v[224:227], 0
    v_mfma_f32_16x16x32_bf16 v[176:179], v[140:143], v[224:227], 0
    s_waitcnt lgkmcnt(6)
    v_mfma_f32_16x16x32_bf16 v[32:35], v[136:139], v[228:231], 0
    v_mfma_f32_16x16x32_bf16 v[36:39], v[140:143], v[228:231], 0
    s_waitcnt lgkmcnt(4)
    v_mfma_f32_16x16x32_bf16 v[40:43], v[136:139], v[232:235], 0
    v_mfma_f32_16x16x32_bf16 v[44:47], v[140:143], v[232:235], 0
    s_waitcnt lgkmcnt(2)
    v_mfma_f32_16x16x32_bf16 v[48:51], v[136:139], v[236:239], 0
    v_mfma_f32_16x16x32_bf16 v[52:55], v[140:143], v[236:239], 0
    s_waitcnt lgkmcnt(0)
    v_mfma_f32_16x16x32_bf16 v[56:59], v[136:139], v[240:243], 0
    v_mfma_f32_16x16x32_bf16 v[60:63], v[140:143], v[240:243], 0
    v_cvt_pk_bf16_f32 v96, v148, v152
    v_cvt_pk_bf16_f32 v97, v156, v160
    v_cvt_pk_bf16_f32 v98, v164, v168
    v_cvt_pk_bf16_f32 v99, v172, v176
    s_add_u32 s4, s93, 0
    buffer_store_dwordx4 v[96:99], v244, s[40:43], s4 offen sc1
    v_cvt_pk_bf16_f32 v100, v149, v153
    v_cvt_pk_bf16_f32 v101, v157, v161
    v_cvt_pk_bf16_f32 v102, v165, v169
    v_cvt_pk_bf16_f32 v103, v173, v177
    s_add_u32 s4, s93, 133120
    buffer_store_dwordx4 v[100:103], v244, s[40:43], s4 offen sc1
    v_cvt_pk_bf16_f32 v104, v150, v154
    v_cvt_pk_bf16_f32 v105, v158, v162
    v_cvt_pk_bf16_f32 v106, v166, v170
    v_cvt_pk_bf16_f32 v107, v174, v178
    s_add_u32 s4, s93, 266240
    buffer_store_dwordx4 v[104:107], v244, s[40:43], s4 offen sc1
    v_cvt_pk_bf16_f32 v108, v151, v155
    v_cvt_pk_bf16_f32 v109, v159, v163
    v_cvt_pk_bf16_f32 v110, v167, v171
    v_cvt_pk_bf16_f32 v111, v175, v179
    s_add_u32 s4, s93, 399360
    buffer_store_dwordx4 v[108:111], v244, s[40:43], s4 offen sc1
    v_cvt_pk_bf16_f32 v112, v32, v36
    v_cvt_pk_bf16_f32 v113, v40, v44
    v_cvt_pk_bf16_f32 v114, v48, v52
    v_cvt_pk_bf16_f32 v115, v56, v60
    s_add_u32 s4, s93, 8320
    buffer_store_dwordx4 v[112:115], v244, s[40:43], s4 offen sc1
    v_cvt_pk_bf16_f32 v116, v33, v37
    v_cvt_pk_bf16_f32 v117, v41, v45
    v_cvt_pk_bf16_f32 v118, v49, v53
    v_cvt_pk_bf16_f32 v119, v57, v61
    s_add_u32 s4, s93, 141440
    buffer_store_dwordx4 v[116:119], v244, s[40:43], s4 offen sc1
    v_cvt_pk_bf16_f32 v120, v34, v38
    v_cvt_pk_bf16_f32 v121, v42, v46
    v_cvt_pk_bf16_f32 v122, v50, v54
    v_cvt_pk_bf16_f32 v123, v58, v62
    s_add_u32 s4, s93, 274560
    buffer_store_dwordx4 v[120:123], v244, s[40:43], s4 offen sc1
    v_cvt_pk_bf16_f32 v124, v35, v39
    v_cvt_pk_bf16_f32 v125, v43, v47
    v_cvt_pk_bf16_f32 v126, v51, v55
    v_cvt_pk_bf16_f32 v127, v59, v63
    s_add_u32 s4, s93, 407680
    buffer_store_dwordx4 v[124:127], v244, s[40:43], s4 offen sc1
    s_cmp_lg_u32 s98, 0
    s_cbranch_scc1 Lny
    s_waitcnt vmcnt(0)
    s_bfm_b64 exec, 4, 0
    buffer_store_dwordx2 v[24:25], v253, s[40:43], s94 offen sc1
    s_mov_b64 exec, -1
Lnb:
    s_cmp_lt_u32 s3, 4
    s_cbranch_scc1 Lc
    s_branch Lred
Lny:
    s_waitcnt vmcnt(8)
    v_lshlrev_b32 v180, 16, v180
    v_lshlrev_b32 v181, 16, v181
    v_lshlrev_b32 v182, 16, v182
    v_lshlrev_b32 v183, 16, v183
    v_lshlrev_b32 v184, 16, v184
    v_lshlrev_b32 v185, 16, v185
    v_lshlrev_b32 v186, 16, v186
    v_lshlrev_b32 v187, 16, v187
    s_lshl_b32 s6, s47, 8
    v_mfma_f32_16x16x32_bf16 v[148:151], v[144:147], v[8:11], 0
    v_mfma_f32_16x16x32_bf16 v[152:155], v[144:147], v[12:15], 0
    s_nop 6
    v_mul_f32 v172, v148, v16
    v_mul_f32 v173, v149, v17
    v_mul_f32 v174, v150, v18
    v_mul_f32 v175, v151, v19
    v_mul_f32 v176, v152, v16
    v_mul_f32 v177, v153, v17
    v_mul_f32 v178, v154, v18
    v_mul_f32 v179, v155, v19
    v_fmac_f32 v172, v152, v20
    v_fmac_f32 v173, v153, v21
    v_fmac_f32 v174, v154, v22
    v_fmac_f32 v175, v155, v23
    v_fma_f32 v176, -v148, v20, v176
    v_fma_f32 v177, -v149, v21, v177
    v_fma_f32 v178, -v150, v22, v178
    v_fma_f32 v179, -v151, v23, v179
    v_cvt_pk_bf16_f32 v212, v172, v176
    v_cvt_pk_bf16_f32 v213, v173, v177
    v_cvt_pk_bf16_f32 v214, v174, v178
    v_cvt_pk_bf16_f32 v215, v175, v179
    s_nop 1
    v_mfma_f32_16x16x32_bf16 v[164:167], v[8:11], v[212:215], 0
    v_mfma_f32_16x16x32_bf16 v[168:171], v[12:15], v[212:215], 0
    s_nop 6
    v_mul_f32 v172, v164, v180
    v_mul_f32 v173, v165, v181
    v_mul_f32 v174, v166, v182
    v_mul_f32 v175, v167, v183
    v_mul_f32 v176, v164, v184
    v_mul_f32 v177, v165, v185
    v_mul_f32 v178, v166, v186
    v_mul_f32 v179, v167, v187
    v_fma_f32 v172, -v168, v184, v172
    v_fma_f32 v173, -v169, v185, v173
    v_fma_f32 v174, -v170, v186, v174
    v_fma_f32 v175, -v171, v187, v175
    v_fmac_f32 v176, v168, v180
    v_fmac_f32 v177, v169, v181
    v_fmac_f32 v178, v170, v182
    v_fmac_f32 v179, v171, v183
    v_cvt_pk_bf16_f32 v144, v176, v172
    v_cvt_pk_bf16_f32 v145, v177, v173
    v_cvt_pk_bf16_f32 v146, v178, v174
    v_cvt_pk_bf16_f32 v147, v179, v175
    s_nop 1
    v_mfma_f32_16x16x32_bf16 v[148:151], v[144:147], v[8:11], 0
    v_mfma_f32_16x16x32_bf16 v[152:155], v[144:147], v[12:15], 0
    s_nop 6
    v_mul_f32 v172, v148, v16
    v_mul_f32 v173, v149, v17
    v_mul_f32 v174, v150, v18
    v_mul_f32 v175, v151, v19
    v_mul_f32 v176, v152, v16
    v_mul_f32 v177, v153, v17
    v_mul_f32 v178, v154, v18
    v_mul_f32 v179, v155, v19
    v_fmac_f32 v172, v152, v20
    v_fmac_f32 v173, v153, v21
    v_fmac_f32 v174, v154, v22
    v_fmac_f32 v175, v155, v23
    v_fma_f32 v176, -v148, v20, v176
    v_fma_f32 v177, -v149, v21, v177
    v_fma_f32 v178, -v150, v22, v178
    v_fma_f32 v179, -v151, v23, v179
    v_cvt_pk_bf16_f32 v212, v172, v176
    v_cvt_pk_bf16_f32 v213, v173, v177
    v_cvt_pk_bf16_f32 v214, v174, v178
    v_cvt_pk_bf16_f32 v215, v175, v179
    s_nop 1
    v_mfma_f32_16x16x32_bf16 v[164:167], v[8:11], v[212:215], 0
    v_mfma_f32_16x16x32_bf16 v[168:171], v[12:15], v[212:215], 0
    s_nop 7
    v_cvt_pk_bf16_f32 v144, v168, v164
    v_cvt_pk_bf16_f32 v145, v169, v165
    v_cvt_pk_bf16_f32 v146, v170, v166
    v_cvt_pk_bf16_f32 v147, v171, v167
    s_add_u32 s7, s6, 0x484000
    buffer_store_dwordx4 v[144:147], v30, s[40:43], s7 offen sc1
    s_waitcnt vmcnt(1)
    s_bfm_b64 exec, 4, 0
    buffer_store_dwordx2 v[24:25], v253, s[40:43], s94 offen sc1
    s_mov_b64 exec, -1
    s_waitcnt vmcnt(1)
    s_bfm_b64 exec, 32, 0
    buffer_store_dwordx2 v[24:25], v252, s[40:43], s100 offen offset:64 sc1
    s_mov_b64 exec, -1
    s_branch Lnb
.p2align 6
Lg2:
    v_mov_b32 v29, 0
    v_mov_b32 v31, 0x20000
    v_lshrrev_b32 v4, 4, v0
    v_and_b32 v4, 28, v4
    v_add_u32 v26, 163072, v4
    v_and_b32 v4, 3, v1
    v_lshlrev_b32 v4, 2, v4
    v_add_u32 v27, 163072, v4
    s_mov_b32 s26, 0x1c0000
    s_mov_b32 s27, 0x20000
    s_mov_b32 s42, 0x10000000
    s_mov_b32 s43, 0x20000
    s_add_u32 s4, s36, 128
    s_and_b32 s37, s4, 0x380
    s_mul_i32 s13, s37, 1792
    s_add_u32 s4, s37, 128
    s_and_b32 s38, s4, 0x380
    s_mul_i32 s14, s38, 1792
    s_add_u32 s4, s38, 128
    s_and_b32 s39, s4, 0x380
    s_mul_i32 s15, s39, 1792
    s_add_u32 s4, s39, 128
    s_and_b32 s54, s4, 0x380
    s_mul_i32 s16, s54, 1792
    s_add_u32 s4, s54, 128
    s_and_b32 s55, s4, 0x380
    s_mul_i32 s17, s55, 1792
    s_add_u32 s4, s55, 128
    s_and_b32 s56, s4, 0x380
    s_mul_i32 s18, s56, 1792
    s_add_u32 s4, s56, 128
    s_and_b32 s57, s4, 0x380
    s_mul_i32 s19, s57, 1792
    s_lshl_b32 s36, s58, 7
    s_add_u32 s4, s36, 128
    s_and_b32 s37, s4, 0x380
    s_add_u32 s4, s37, 128
    s_and_b32 s38, s4, 0x380
    s_add_u32 s4, s38, 128
    s_and_b32 s39, s4, 0x380
    s_add_u32 s4, s39, 128
    s_and_b32 s54, s4, 0x380
    s_add_u32 s4, s54, 128
    s_and_b32 s55, s4, 0x380
    s_add_u32 s4, s55, 128
    s_and_b32 s56, s4, 0x380
    s_add_u32 s4, s56, 128
    s_and_b32 s57, s4, 0x380
    s_and_b32 s4, s36, 0x80
    s_lshl_b32 s5, s36, 1
    s_sub_u32 s5, s5, s4
    s_lshl_b32 s28, s5, 7
    s_and_b32 s4, s37, 0x80
    s_lshl_b32 s5, s37, 1
    s_sub_u32 s5, s5, s4
    s_lshl_b32 s29, s5, 7
    s_and_b32 s4, s38, 0x80
    s_lshl_b32 s5, s38, 1
    s_sub_u32 s5, s5, s4
    s_lshl_b32 s30, s5, 7
    s_and_b32 s4, s39, 0x80
    s_lshl_b32 s5, s39, 1
    s_sub_u32 s5, s5, s4
    s_lshl_b32 s31, s5, 7
    s_and_b32 s4, s54, 0x80
    s_lshl_b32 s5, s54, 1
    s_sub_u32 s5, s5, s4
    s_lshl_b32 s32, s5, 7
    s_and_b32 s4, s55, 0x80
    s_lshl_b32 s5, s55, 1
    s_sub_u32 s5, s5, s4
    s_lshl_b32 s33, s5, 7
    s_and_b32 s4, s56, 0x80
    s_lshl_b32 s5, s56, 1
    s_sub_u32 s5, s5, s4
    s_lshl_b32 s34, s5, 7
    s_and_b32 s4, s57, 0x80
    s_lshl_b32 s5, s57, 1
    s_sub_u32 s5, s5, s4
    s_lshl_b32 s35, s5, 7
    s_load_dwordx2 s[36:37], s[0:1], 64
    v_lshrrev_b32 v5, 3, v1
    v_lshl_add_u32 v7, v5, 10, v6
    s_lshl_b32 s4, s46, 18
    s_lshl_b32 s5, s45, 8
    s_add_u32 s4, s4, s5
    v_add_u32 v194, s4, v7
    v_add_u32 v195, 7168, v194
    v_lshrrev_b32 v5, 5, v1
    v_lshlrev_b32 v6, 10, v5
    v_lshrrev_b32 v7, 2, v2
    v_lshl_add_u32 v6, v7, 7, v6
    v_lshrrev_b32 v7, 3, v2
    v_lshl_add_u32 v6, v7, 6, v6
    v_and_b32 v7, 1, v3
    v_lshl_add_u32 v6, v7, 5, v6
    v_and_b32 v7, 1, v1
    v_lshl_add_u32 v6, v7, 4, v6
    v_bfe_u32 v7, v1, 1, 1
    v_lshl_add_u32 v6, v7, 3, v6
    v_add_u32 v204, s93, v6
    s_lshl_b32 s5, s45, 14
    v_add_u32 v206, s5, v6
    s_add_u32 s5, s5, 8192
    v_add_u32 v203, s5, v30
    s_lshl_b32 s5, s45, 12
    s_add_u32 s97, s5, 139264
    v_add_u32 v208, s97, v6
    v_xor_b32 v205, 64, v204
    v_xor_b32 v207, 64, v206
    v_xor_b32 v209, 64, v208
    v_and_b32 v7, 31, v1
    v_bfe_u32 v6, v1, 1, 3
    v_xor_b32 v6, v6, v5
    v_lshlrev_b32 v6, 4, v6
    v_lshl_add_u32 v210, v7, 7, v6
    v_xor_b32 v211, 32, v210
    v_xor_b32 v212, 64, v210
    v_xor_b32 v213, 96, v210
    v_add_u32 v198, 65536, v30
    v_lshrrev_b32 v5, 5, v1
    v_and_b32 v4, 7, v1
    v_lshlrev_b32 v4, 4, v4
    v_lshl_add_u32 v4, v5, 7, v4
    v_bfe_u32 v6, v1, 3, 2
    v_lshl_add_u32 v199, v6, 16, v4
    s_and_b32 s5, s46, 3
    s_lshl_b32 s5, s5, 3
    s_lshl_b32 s5, 0xff, s5
    s_cmp_lt_u32 s46, 4
    s_cselect_b32 s50, s5, 0
    s_cselect_b32 s52, 0, s5
    s_mov_b32 s51, s50
    s_mov_b32 s53, s52
    v_bfrev_b32 v6, 1
    v_cndmask_b32_e64 v200, v199, v6, s[52:53]
    v_cndmask_b32_e64 v199, v199, v6, s[50:51]
    s_lshl_b32 s5, s47, 19
    s_lshl3_add_u32 s6, s46, s45
    s_lshl_b32 s6, s6, 10
    s_add_u32 s5, s5, s6
    s_add_u32 s95, s5, 0x800000
    v_lshlrev_b32 v202, 10, v1
    s_lshl_b32 s5, s47, 13
    s_lshl4_add_u32 s6, s45, s46
    s_lshl3_add_u32 s5, s6, s5
    s_add_u32 s96, s5, 0x4a0000
    s_add_u32 s5, s93, 8192
    v_add_u32 v201, s5, v4
    s_lshl_b32 s5, s45, 1
    s_sub_u32 s5, s5, s58
    s_and_b32 s6, s5, 7
    s_lshl_b32 s6, s6, 11
    s_add_u32 s6, s6, 65536
    v_add_u32 v4, s6, v30
    s_add_u32 s5, s5, 1
    s_and_b32 s6, s5, 7
    s_lshl_b32 s6, s6, 11
    s_add_u32 s6, s6, 65536
    v_add_u32 v5, s6, v30
    s_lshl_b32 s6, s45, 12
    s_add_u32 s6, s6, 139264
    v_add_u32 v6, s6, v30
    s_waitcnt vmcnt(8)
    v_mov_b32 v28, 1
    s_mov_b64 exec, 1
    ds_write_b32 v26, v28
    s_mov_b64 exec, -1
    s_add_u32 m0, s93, 8192
    s_nop 0
    buffer_load_dwordx4 v192, s[20:23], s13 offen lds
    buffer_load_dwordx4 v193, s[20:23], s13 offen offset:1024 lds
    s_add_u32 m0, s97, 0
    s_add_u32 s7, s13, 57344
    buffer_load_dwordx4 v192, s[20:23], s7 offen lds
    buffer_load_dwordx4 v193, s[20:23], s7 offen offset:1024 lds
    s_add_u32 m0, s97, 2048
    s_add_u32 s7, s13, 114688
    buffer_load_dwordx4 v192, s[20:23], s7 offen lds
    buffer_load_dwordx4 v193, s[20:23], s7 offen offset:1024 lds
    s_mov_b32 s92, 0x1000000
L38:
    ds_read_b32 v28, v27 offset:16
    s_sub_u32 s92, s92, 1
    s_cbranch_scc1 L39
    s_waitcnt lgkmcnt(0)
    v_cmp_gt_u32 vcc, 1, v28
    s_cbranch_vccnz L38
L39:
    ds_read_b128 v[176:179], v210 offset:0
    ds_read_b128 v[180:183], v210 offset:4096
    s_waitcnt vmcnt(12)
    ds_read_b64_tr_b16 v[160:161], v204 offset:0
    ds_read_b64_tr_b16 v[162:163], v204 offset:512
    ds_read_b64_tr_b16 v[164:165], v205 offset:0
    ds_read_b64_tr_b16 v[166:167], v205 offset:512
    s_waitcnt lgkmcnt(0)
    v_mfma_f32_32x32x16_bf16 v[32:47], v[160:163], v[176:179], 0
    ds_read_b128 v[184:187], v211 offset:0
    ds_read_b128 v[188:191], v211 offset:4096
    s_waitcnt vmcnt(10)
    ds_read_b64_tr_b16 v[168:169], v204 offset:2048
    v_mfma_f32_32x32x16_bf16 v[48:63], v[160:163], v[180:183], 0
    ds_read_b64_tr_b16 v[170:171], v204 offset:2560
    ds_read_b64_tr_b16 v[172:173], v205 offset:2048
    ds_read_b64_tr_b16 v[174:175], v205 offset:2560
    s_add_u32 m0, s93, 0
    s_add_u32 s7, s13, 172032
    v_mfma_f32_32x32x16_bf16 v[64:79], v[164:167], v[176:179], 0
    buffer_load_dwordx4 v192, s[20:23], s7 offen lds
    buffer_load_dwordx4 v193, s[20:23], s7 offen offset:1024 lds
    v_mfma_f32_32x32x16_bf16 v[80:95], v[164:167], v[180:183], 0
    s_waitcnt lgkmcnt(0)
    v_mfma_f32_32x32x16_bf16 v[32:47], v[168:171], v[184:187], v[32:47]
    ds_read_b128 v[176:179], v212 offset:0
    ds_read_b128 v[180:183], v212 offset:4096
    s_waitcnt vmcnt(10)
    ds_read_b64_tr_b16 v[160:161], v204 offset:4096
    v_mfma_f32_32x32x16_bf16 v[48:63], v[168:171], v[188:191], v[48:63]
    ds_read_b64_tr_b16 v[162:163], v204 offset:4608
    ds_read_b64_tr_b16 v[164:165], v205 offset:4096
    ds_read_b64_tr_b16 v[166:167], v205 offset:4608
    s_add_u32 m0, s93, 2048
    v_mfma_f32_32x32x16_bf16 v[64:79], v[172:175], v[184:187], v[64:79]
    buffer_load_dwordx4 v192, s[20:23], s14 offen lds
    buffer_load_dwordx4 v193, s[20:23], s14 offen offset:1024 lds
    v_mfma_f32_32x32x16_bf16 v[80:95], v[172:175], v[188:191], v[80:95]
    s_waitcnt lgkmcnt(0)
    v_mfma_f32_32x32x16_bf16 v[32:47], v[160:163], v[176:179], v[32:47]
    ds_read_b128 v[184:187], v213 offset:0
    ds_read_b128 v[188:191], v213 offset:4096
    s_waitcnt vmcnt(10)
    ds_read_b64_tr_b16 v[168:169], v204 offset:6144
    v_mfma_f32_32x32x16_bf16 v[48:63], v[160:163], v[180:183], v[48:63]
    ds_read_b64_tr_b16 v[170:171], v204 offset:6656
    ds_read_b64_tr_b16 v[172:173], v205 offset:6144
    ds_read_b64_tr_b16 v[174:175], v205 offset:6656
    s_add_u32 m0, s93, 4096
    s_add_u32 s7, s14, 57344
    v_mfma_f32_32x32x16_bf16 v[64:79], v[164:167], v[176:179], v[64:79]
    buffer_load_dwordx4 v192, s[20:23], s7 offen lds
    buffer_load_dwordx4 v193, s[20:23], s7 offen offset:1024 lds
    v_mfma_f32_32x32x16_bf16 v[80:95], v[164:167], v[180:183], v[80:95]
    s_waitcnt lgkmcnt(0)
    v_mfma_f32_32x32x16_bf16 v[32:47], v[168:171], v[184:187], v[32:47]
    ds_read_b128 v[176:179], v210 offset:8192
    ds_read_b128 v[180:183], v210 offset:12288
    s_waitcnt vmcnt(10)
    ds_read_b64_tr_b16 v[160:161], v204 offset:8192
    v_mfma_f32_32x32x16_bf16 v[48:63], v[168:171], v[188:191], v[48:63]
    ds_read_b64_tr_b16 v[162:163], v204 offset:8704
    ds_read_b64_tr_b16 v[164:165], v205 offset:8192
    ds_read_b64_tr_b16 v[166:167], v205 offset:8704
    s_add_u32 m0, s93, 6144
    s_add_u32 s7, s14, 114688
    v_mfma_f32_32x32x16_bf16 v[64:79], v[172:175], v[184:187], v[64:79]
    buffer_load_dwordx4 v192, s[20:23], s7 offen lds
    buffer_load_dwordx4 v193, s[20:23], s7 offen offset:1024 lds
    v_mfma_f32_32x32x16_bf16 v[80:95], v[172:175], v[188:191], v[80:95]
    s_waitcnt lgkmcnt(0)
    v_mfma_f32_32x32x16_bf16 v[32:47], v[160:163], v[176:179], v[32:47]
    ds_read_b128 v[184:187], v211 offset:8192
    ds_read_b128 v[188:191], v211 offset:12288
    s_waitcnt vmcnt(10)
    ds_read_b64_tr_b16 v[168:169], v208 offset:0
    v_mfma_f32_32x32x16_bf16 v[48:63], v[160:163], v[180:183], v[48:63]
    ds_read_b64_tr_b16 v[170:171], v208 offset:512
    ds_read_b64_tr_b16 v[172:173], v209 offset:0
    ds_read_b64_tr_b16 v[174:175], v209 offset:512
    s_add_u32 m0, s93, 8192
    s_add_u32 s7, s14, 172032
    v_mfma_f32_32x32x16_bf16 v[64:79], v[164:167], v[176:179], v[64:79]
    buffer_load_dwordx4 v192, s[20:23], s7 offen lds
    buffer_load_dwordx4 v193, s[20:23], s7 offen offset:1024 lds
    v_mfma_f32_32x32x16_bf16 v[80:95], v[164:167], v[180:183], v[80:95]
    s_waitcnt lgkmcnt(0)
    v_mfma_f32_32x32x16_bf16 v[32:47], v[168:171], v[184:187], v[32:47]
    ds_read_b128 v[176:179], v212 offset:8192
    ds_read_b128 v[180:183], v212 offset:12288
    s_waitcnt vmcnt(10)
    ds_read_b64_tr_b16 v[160:161], v208 offset:2048
    v_mfma_f32_32x32x16_bf16 v[48:63], v[168:171], v[188:191], v[48:63]
    ds_read_b64_tr_b16 v[162:163], v208 offset:2560
    ds_read_b64_tr_b16 v[164:165], v209 offset:2048
    ds_read_b64_tr_b16 v[166:167], v209 offset:2560
    s_add_u32 m0, s97, 0
    v_mfma_f32_32x32x16_bf16 v[64:79], v[172:175], v[184:187], v[64:79]
    buffer_load_dwordx4 v192, s[20:23], s15 offen lds
    buffer_load_dwordx4 v193, s[20:23], s15 offen offset:1024 lds
    v_mfma_f32_32x32x16_bf16 v[80:95], v[172:175], v[188:191], v[80:95]
    s_waitcnt lgkmcnt(0)
    v_mfma_f32_32x32x16_bf16 v[32:47], v[160:163], v[176:179], v[32:47]
    ds_read_b128 v[184:187], v213 offset:8192
    ds_read_b128 v[188:191], v213 offset:12288
    s_waitcnt vmcnt(10)
    ds_read_b64_tr_b16 v[168:169], v204 offset:0
    v_mfma_f32_32x32x16_bf16 v[48:63], v[160:163], v[180:183], v[48:63]
    ds_read_b64_tr_b16 v[170:171], v204 offset:512
    ds_read_b64_tr_b16 v[172:173], v205 offset:0
    ds_read_b64_tr_b16 v[174:175], v205 offset:512
    s_add_u32 m0, s97, 2048
    s_add_u32 s7, s15, 57344
    v_mfma_f32_32x32x16_bf16 v[64:79], v[164:167], v[176:179], v[64:79]
    buffer_load_dwordx4 v192, s[20:23], s7 offen lds
    buffer_load_dwordx4 v193, s[20:23], s7 offen offset:1024 lds
    v_mfma_f32_32x32x16_bf16 v[80:95], v[164:167], v[180:183], v[80:95]
    s_waitcnt lgkmcnt(0)
    v_mfma_f32_32x32x16_bf16 v[32:47], v[168:171], v[184:187], v[32:47]
    ds_read_b128 v[176:179], v210 offset:16384
    ds_read_b128 v[180:183], v210 offset:20480
    s_waitcnt vmcnt(10)
    ds_read_b64_tr_b16 v[160:161], v204 offset:2048
    v_mfma_f32_32x32x16_bf16 v[48:63], v[168:171], v[188:191], v[48:63]
    ds_read_b64_tr_b16 v[162:163], v204 offset:2560
    ds_read_b64_tr_b16 v[164:165], v205 offset:2048
    ds_read_b64_tr_b16 v[166:167], v205 offset:2560
    s_add_u32 m0, s93, 0
    s_add_u32 s7, s15, 114688
    v_mfma_f32_32x32x16_bf16 v[64:79], v[172:175], v[184:187], v[64:79]
    buffer_load_dwordx4 v192, s[20:23], s7 offen lds
    buffer_load_dwordx4 v193, s[20:23], s7 offen offset:1024 lds
    v_mfma_f32_32x32x16_bf16 v[80:95], v[172:175], v[188:191], v[80:95]
    s_waitcnt lgkmcnt(0)
    v_mfma_f32_32x32x16_bf16 v[32:47], v[160:163], v[176:179], v[32:47]
    ds_read_b128 v[184:187], v211 offset:16384
    ds_read_b128 v[188:191], v211 offset:20480
    s_waitcnt vmcnt(10)
    ds_read_b64_tr_b16 v[168:169], v204 offset:4096
    v_mfma_f32_32x32x16_bf16 v[48:63], v[160:163], v[180:183], v[48:63]
    ds_read_b64_tr_b16 v[170:171], v204 offset:4608
    ds_read_b64_tr_b16 v[172:173], v205 offset:4096
    ds_read_b64_tr_b16 v[174:175], v205 offset:4608
    s_add_u32 m0, s93, 2048
    s_add_u32 s7, s15, 172032
    v_mfma_f32_32x32x16_bf16 v[64:79], v[164:167], v[176:179], v[64:79]
    buffer_load_dwordx4 v192, s[20:23], s7 offen lds
    buffer_load_dwordx4 v193, s[20:23], s7 offen offset:1024 lds
    v_mfma_f32_32x32x16_bf16 v[80:95], v[164:167], v[180:183], v[80:95]
    s_waitcnt lgkmcnt(0)
    v_mfma_f32_32x32x16_bf16 v[32:47], v[168:171], v[184:187], v[32:47]
    ds_read_b128 v[176:179], v212 offset:16384
    ds_read_b128 v[180:183], v212 offset:20480
    s_waitcnt vmcnt(10)
    ds_read_b64_tr_b16 v[160:161], v204 offset:6144
    v_mfma_f32_32x32x16_bf16 v[48:63], v[168:171], v[188:191], v[48:63]
    ds_read_b64_tr_b16 v[162:163], v204 offset:6656
    ds_read_b64_tr_b16 v[164:165], v205 offset:6144
    ds_read_b64_tr_b16 v[166:167], v205 offset:6656
    s_add_u32 m0, s93, 4096
    v_mfma_f32_32x32x16_bf16 v[64:79], v[172:175], v[184:187], v[64:79]
    buffer_load_dwordx4 v192, s[20:23], s16 offen lds
    buffer_load_dwordx4 v193, s[20:23], s16 offen offset:1024 lds
    v_mfma_f32_32x32x16_bf16 v[80:95], v[172:175], v[188:191], v[80:95]
    s_waitcnt lgkmcnt(0)
    v_mfma_f32_32x32x16_bf16 v[32:47], v[160:163], v[176:179], v[32:47]
    ds_read_b128 v[184:187], v213 offset:16384
    ds_read_b128 v[188:191], v213 offset:20480
    s_waitcnt vmcnt(10)
    ds_read_b64_tr_b16 v[168:169], v204 offset:8192
    v_mfma_f32_32x32x16_bf16 v[48:63], v[160:163], v[180:183], v[48:63]
    ds_read_b64_tr_b16 v[170:171], v204 offset:8704
    ds_read_b64_tr_b16 v[172:173], v205 offset:8192
    ds_read_b64_tr_b16 v[174:175], v205 offset:8704
    s_add_u32 m0, s93, 6144
    s_add_u32 s7, s16, 57344
    v_mfma_f32_32x32x16_bf16 v[64:79], v[164:167], v[176:179], v[64:79]
    buffer_load_dwordx4 v192, s[20:23], s7 offen lds
    buffer_load_dwordx4 v193, s[20:23], s7 offen offset:1024 lds
    v_mfma_f32_32x32x16_bf16 v[80:95], v[164:167], v[180:183], v[80:95]
    s_waitcnt lgkmcnt(0)
    v_mfma_f32_32x32x16_bf16 v[32:47], v[168:171], v[184:187], v[32:47]
    ds_read_b128 v[176:179], v210 offset:24576
    ds_read_b128 v[180:183], v210 offset:28672
    s_waitcnt vmcnt(10)
    ds_read_b64_tr_b16 v[160:161], v208 offset:0
    v_mfma_f32_32x32x16_bf16 v[48:63], v[168:171], v[188:191], v[48:63]
    ds_read_b64_tr_b16 v[162:163], v208 offset:512
    ds_read_b64_tr_b16 v[164:165], v209 offset:0
    ds_read_b64_tr_b16 v[166:167], v209 offset:512
    s_add_u32 m0, s93, 8192
    s_add_u32 s7, s16, 114688
    v_mfma_f32_32x32x16_bf16 v[64:79], v[172:175], v[184:187], v[64:79]
    buffer_load_dwordx4 v192, s[20:23], s7 offen lds
    buffer_load_dwordx4 v193, s[20:23], s7 offen offset:1024 lds
    v_mfma_f32_32x32x16_bf16 v[80:95], v[172:175], v[188:191], v[80:95]
    s_waitcnt lgkmcnt(0)
    v_mfma_f32_32x32x16_bf16 v[32:47], v[160:163], v[176:179], v[32:47]
    ds_read_b128 v[184:187], v211 offset:24576
    ds_read_b128 v[188:191], v211 offset:28672
    s_waitcnt vmcnt(10)
    ds_read_b64_tr_b16 v[168:169], v208 offset:2048
    v_mfma_f32_32x32x16_bf16 v[48:63], v[160:163], v[180:183], v[48:63]
    ds_read_b64_tr_b16 v[170:171], v208 offset:2560
    ds_read_b64_tr_b16 v[172:173], v209 offset:2048
    ds_read_b64_tr_b16 v[174:175], v209 offset:2560
    s_add_u32 m0, s97, 0
    s_add_u32 s7, s16, 172032
    v_mfma_f32_32x32x16_bf16 v[64:79], v[164:167], v[176:179], v[64:79]
    buffer_load_dwordx4 v192, s[20:23], s7 offen lds
    buffer_load_dwordx4 v193, s[20:23], s7 offen offset:1024 lds
    v_mfma_f32_32x32x16_bf16 v[80:95], v[164:167], v[180:183], v[80:95]
    s_waitcnt lgkmcnt(0)
    v_mfma_f32_32x32x16_bf16 v[32:47], v[168:171], v[184:187], v[32:47]
    ds_read_b128 v[176:179], v212 offset:24576
    ds_read_b128 v[180:183], v212 offset:28672
    s_waitcnt vmcnt(10)
    ds_read_b64_tr_b16 v[160:161], v204 offset:0
    v_mfma_f32_32x32x16_bf16 v[48:63], v[168:171], v[188:191], v[48:63]
    ds_read_b64_tr_b16 v[162:163], v204 offset:512
    ds_read_b64_tr_b16 v[164:165], v205 offset:0
    ds_read_b64_tr_b16 v[166:167], v205 offset:512
    s_add_u32 m0, s97, 2048
    v_mfma_f32_32x32x16_bf16 v[64:79], v[172:175], v[184:187], v[64:79]
    buffer_load_dwordx4 v192, s[20:23], s17 offen lds
    buffer_load_dwordx4 v193, s[20:23], s17 offen offset:1024 lds
    v_mfma_f32_32x32x16_bf16 v[80:95], v[172:175], v[188:191], v[80:95]
    s_waitcnt lgkmcnt(0)
    v_mfma_f32_32x32x16_bf16 v[32:47], v[160:163], v[176:179], v[32:47]
    ds_read_b128 v[184:187], v213 offset:24576
    ds_read_b128 v[188:191], v213 offset:28672
    s_waitcnt vmcnt(10)
    ds_read_b64_tr_b16 v[168:169], v204 offset:2048
    v_mfma_f32_32x32x16_bf16 v[48:63], v[160:163], v[180:183], v[48:63]
    ds_read_b64_tr_b16 v[170:171], v204 offset:2560
    ds_read_b64_tr_b16 v[172:173], v205 offset:2048
    ds_read_b64_tr_b16 v[174:175], v205 offset:2560
    s_add_u32 m0, s93, 0
    s_add_u32 s7, s17, 57344
    v_mfma_f32_32x32x16_bf16 v[64:79], v[164:167], v[176:179], v[64:79]
    buffer_load_dwordx4 v192, s[20:23], s7 offen lds
    buffer_load_dwordx4 v193, s[20:23], s7 offen offset:1024 lds
    v_mfma_f32_32x32x16_bf16 v[80:95], v[164:167], v[180:183], v[80:95]
    s_waitcnt lgkmcnt(0)
    v_mfma_f32_32x32x16_bf16 v[32:47], v[168:171], v[184:187], v[32:47]
    ds_read_b128 v[176:179], v210 offset:32768
    ds_read_b128 v[180:183], v210 offset:36864
    s_waitcnt vmcnt(10)
    ds_read_b64_tr_b16 v[160:161], v204 offset:4096
    v_mfma_f32_32x32x16_bf16 v[48:63], v[168:171], v[188:191], v[48:63]
    ds_read_b64_tr_b16 v[162:163], v204 offset:4608
    ds_read_b64_tr_b16 v[164:165], v205 offset:4096
    ds_read_b64_tr_b16 v[166:167], v205 offset:4608
    s_add_u32 m0, s93, 2048
    s_add_u32 s7, s17, 114688
    v_mfma_f32_32x32x16_bf16 v[64:79], v[172:175], v[184:187], v[64:79]
    buffer_load_dwordx4 v192, s[20:23], s7 offen lds
    buffer_load_dwordx4 v193, s[20:23], s7 offen offset:1024 lds
    v_mfma_f32_32x32x16_bf16 v[80:95], v[172:175], v[188:191], v[80:95]
    s_waitcnt lgkmcnt(0)
    v_mfma_f32_32x32x16_bf16 v[32:47], v[160:163], v[176:179], v[32:47]
    ds_read_b128 v[184:187], v211 offset:32768
    ds_read_b128 v[188:191], v211 offset:36864
    s_waitcnt vmcnt(10)
    ds_read_b64_tr_b16 v[168:169], v204 offset:6144
    v_mfma_f32_32x32x16_bf16 v[48:63], v[160:163], v[180:183], v[48:63]
    ds_read_b64_tr_b16 v[170:171], v204 offset:6656
    ds_read_b64_tr_b16 v[172:173], v205 offset:6144
    ds_read_b64_tr_b16 v[174:175], v205 offset:6656
    s_add_u32 m0, s93, 4096
    s_add_u32 s7, s17, 172032
    v_mfma_f32_32x32x16_bf16 v[64:79], v[164:167], v[176:179], v[64:79]
    buffer_load_dwordx4 v192, s[20:23], s7 offen lds
    buffer_load_dwordx4 v193, s[20:23], s7 offen offset:1024 lds
    v_mfma_f32_32x32x16_bf16 v[80:95], v[164:167], v[180:183], v[80:95]
    s_waitcnt lgkmcnt(0)
    v_mfma_f32_32x32x16_bf16 v[32:47], v[168:171], v[184:187], v[32:47]
    ds_read_b128 v[176:179], v212 offset:32768
    ds_read_b128 v[180:183], v212 offset:36864
    s_waitcnt vmcnt(10)
    ds_read_b64_tr_b16 v[160:161], v204 offset:8192
    v_mfma_f32_32x32x16_bf16 v[48:63], v[168:171], v[188:191], v[48:63]
    ds_read_b64_tr_b16 v[162:163], v204 offset:8704
    ds_read_b64_tr_b16 v[164:165], v205 offset:8192
    ds_read_b64_tr_b16 v[166:167], v205 offset:8704
    s_add_u32 m0, s93, 6144
    v_mfma_f32_32x32x16_bf16 v[64:79], v[172:175], v[184:187], v[64:79]
    buffer_load_dwordx4 v192, s[20:23], s18 offen lds
    buffer_load_dwordx4 v193, s[20:23], s18 offen offset:1024 lds
    v_mfma_f32_32x32x16_bf16 v[80:95], v[172:175], v[188:191], v[80:95]
    s_waitcnt lgkmcnt(0)
    v_mfma_f32_32x32x16_bf16 v[32:47], v[160:163], v[176:179], v[32:47]
    ds_read_b128 v[184:187], v213 offset:32768
    ds_read_b128 v[188:191], v213 offset:36864
    s_waitcnt vmcnt(10)
    ds_read_b64_tr_b16 v[168:169], v208 offset:0
    v_mfma_f32_32x32x16_bf16 v[48:63], v[160:163], v[180:183], v[48:63]
    ds_read_b64_tr_b16 v[170:171], v208 offset:512
    ds_read_b64_tr_b16 v[172:173], v209 offset:0
    ds_read_b64_tr_b16 v[174:175], v209 offset:512
    s_add_u32 m0, s93, 8192
    s_add_u32 s7, s18, 57344
    v_mfma_f32_32x32x16_bf16 v[64:79], v[164:167], v[176:179], v[64:79]
    buffer_load_dwordx4 v192, s[20:23], s7 offen lds
    buffer_load_dwordx4 v193, s[20:23], s7 offen offset:1024 lds
    v_mfma_f32_32x32x16_bf16 v[80:95], v[164:167], v[180:183], v[80:95]
    s_waitcnt lgkmcnt(0)
    v_mfma_f32_32x32x16_bf16 v[32:47], v[168:171], v[184:187], v[32:47]
    ds_read_b128 v[176:179], v210 offset:40960
    ds_read_b128 v[180:183], v210 offset:45056
    s_waitcnt vmcnt(10)
    ds_read_b64_tr_b16 v[160:161], v208 offset:2048
    v_mfma_f32_32x32x16_bf16 v[48:63], v[168:171], v[188:191], v[48:63]
    ds_read_b64_tr_b16 v[162:163], v208 offset:2560
    ds_read_b64_tr_b16 v[164:165], v209 offset:2048
    ds_read_b64_tr_b16 v[166:167], v209 offset:2560
    s_add_u32 m0, s97, 0
    s_add_u32 s7, s18, 114688
    v_mfma_f32_32x32x16_bf16 v[64:79], v[172:175], v[184:187], v[64:79]
    buffer_load_dwordx4 v192, s[20:23], s7 offen lds
    buffer_load_dwordx4 v193, s[20:23], s7 offen offset:1024 lds
    v_mfma_f32_32x32x16_bf16 v[80:95], v[172:175], v[188:191], v[80:95]
    s_waitcnt lgkmcnt(0)
    v_mfma_f32_32x32x16_bf16 v[32:47], v[160:163], v[176:179], v[32:47]
    ds_read_b128 v[184:187], v211 offset:40960
    ds_read_b128 v[188:191], v211 offset:45056
    s_waitcnt vmcnt(10)
    ds_read_b64_tr_b16 v[168:169], v204 offset:0
    v_mfma_f32_32x32x16_bf16 v[48:63], v[160:163], v[180:183], v[48:63]
    ds_read_b64_tr_b16 v[170:171], v204 offset:512
    ds_read_b64_tr_b16 v[172:173], v205 offset:0
    ds_read_b64_tr_b16 v[174:175], v205 offset:512
    s_add_u32 m0, s97, 2048
    s_add_u32 s7, s18, 172032
    v_mfma_f32_32x32x16_bf16 v[64:79], v[164:167], v[176:179], v[64:79]
    buffer_load_dwordx4 v192, s[20:23], s7 offen lds
    buffer_load_dwordx4 v193, s[20:23], s7 offen offset:1024 lds
    v_mfma_f32_32x32x16_bf16 v[80:95], v[164:167], v[180:183], v[80:95]
    s_waitcnt lgkmcnt(0)
    v_mfma_f32_32x32x16_bf16 v[32:47], v[168:171], v[184:187], v[32:47]
    ds_read_b128 v[176:179], v212 offset:40960
    ds_read_b128 v[180:183], v212 offset:45056
    s_waitcnt vmcnt(10)
    ds_read_b64_tr_b16 v[160:161], v204 offset:2048
    v_mfma_f32_32x32x16_bf16 v[48:63], v[168:171], v[188:191], v[48:63]
    ds_read_b64_tr_b16 v[162:163], v204 offset:2560
    ds_read_b64_tr_b16 v[164:165], v205 offset:2048
    ds_read_b64_tr_b16 v[166:167], v205 offset:2560
    s_add_u32 m0, s93, 0
    v_mfma_f32_32x32x16_bf16 v[64:79], v[172:175], v[184:187], v[64:79]
    buffer_load_dwordx4 v192, s[20:23], s19 offen lds
    buffer_load_dwordx4 v193, s[20:23], s19 offen offset:1024 lds
    v_mfma_f32_32x32x16_bf16 v[80:95], v[172:175], v[188:191], v[80:95]
    s_waitcnt lgkmcnt(0)
    v_mfma_f32_32x32x16_bf16 v[32:47], v[160:163], v[176:179], v[32:47]
    ds_read_b128 v[184:187], v213 offset:40960
    ds_read_b128 v[188:191], v213 offset:45056
    s_waitcnt vmcnt(10)
    ds_read_b64_tr_b16 v[168:169], v204 offset:4096
    v_mfma_f32_32x32x16_bf16 v[48:63], v[160:163], v[180:183], v[48:63]
    ds_read_b64_tr_b16 v[170:171], v204 offset:4608
    ds_read_b64_tr_b16 v[172:173], v205 offset:4096
    ds_read_b64_tr_b16 v[174:175], v205 offset:4608
    s_add_u32 m0, s93, 2048
    s_add_u32 s7, s19, 57344
    v_mfma_f32_32x32x16_bf16 v[64:79], v[164:167], v[176:179], v[64:79]
    buffer_load_dwordx4 v192, s[20:23], s7 offen lds
    buffer_load_dwordx4 v193, s[20:23], s7 offen offset:1024 lds
    v_mfma_f32_32x32x16_bf16 v[80:95], v[164:167], v[180:183], v[80:95]
    s_waitcnt lgkmcnt(0)
    v_mfma_f32_32x32x16_bf16 v[32:47], v[168:171], v[184:187], v[32:47]
    ds_read_b128 v[176:179], v210 offset:49152
    ds_read_b128 v[180:183], v210 offset:53248
    s_waitcnt vmcnt(10)
    ds_read_b64_tr_b16 v[160:161], v204 offset:6144
    v_mfma_f32_32x32x16_bf16 v[48:63], v[168:171], v[188:191], v[48:63]
    ds_read_b64_tr_b16 v[162:163], v204 offset:6656
    ds_read_b64_tr_b16 v[164:165], v205 offset:6144
    ds_read_b64_tr_b16 v[166:167], v205 offset:6656
    s_add_u32 m0, s93, 4096
    s_add_u32 s7, s19, 114688
    v_mfma_f32_32x32x16_bf16 v[64:79], v[172:175], v[184:187], v[64:79]
    buffer_load_dwordx4 v192, s[20:23], s7 offen lds
    buffer_load_dwordx4 v193, s[20:23], s7 offen offset:1024 lds
    v_mfma_f32_32x32x16_bf16 v[80:95], v[172:175], v[188:191], v[80:95]
    s_waitcnt lgkmcnt(0)
    v_mfma_f32_32x32x16_bf16 v[32:47], v[160:163], v[176:179], v[32:47]
    ds_read_b128 v[184:187], v211 offset:49152
    ds_read_b128 v[188:191], v211 offset:53248
    s_waitcnt vmcnt(10)
    ds_read_b64_tr_b16 v[168:169], v204 offset:8192
    v_mfma_f32_32x32x16_bf16 v[48:63], v[160:163], v[180:183], v[48:63]
    ds_read_b64_tr_b16 v[170:171], v204 offset:8704
    ds_read_b64_tr_b16 v[172:173], v205 offset:8192
    ds_read_b64_tr_b16 v[174:175], v205 offset:8704
    s_add_u32 m0, s93, 6144
    s_add_u32 s7, s19, 172032
    v_mfma_f32_32x32x16_bf16 v[64:79], v[164:167], v[176:179], v[64:79]
    buffer_load_dwordx4 v192, s[20:23], s7 offen lds
    buffer_load_dwordx4 v193, s[20:23], s7 offen offset:1024 lds
    v_mfma_f32_32x32x16_bf16 v[80:95], v[164:167], v[180:183], v[80:95]
    s_waitcnt lgkmcnt(0)
    v_mfma_f32_32x32x16_bf16 v[32:47], v[168:171], v[184:187], v[32:47]
    ds_read_b128 v[176:179], v212 offset:49152
    ds_read_b128 v[180:183], v212 offset:53248
    s_waitcnt vmcnt(10)
    ds_read_b64_tr_b16 v[160:161], v208 offset:0
    v_mfma_f32_32x32x16_bf16 v[48:63], v[168:171], v[188:191], v[48:63]
    ds_read_b64_tr_b16 v[162:163], v208 offset:512
    ds_read_b64_tr_b16 v[164:165], v209 offset:0
    ds_read_b64_tr_b16 v[166:167], v209 offset:512
    s_add_u32 m0, s93, 8192
    v_mfma_f32_32x32x16_bf16 v[64:79], v[172:175], v[184:187], v[64:79]
    buffer_load_dwordx4 v194, s[24:27], s28 offen lds
    buffer_load_dwordx4 v195, s[24:27], s28 offen offset:1024 lds
    v_mfma_f32_32x32x16_bf16 v[80:95], v[172:175], v[188:191], v[80:95]
    s_waitcnt lgkmcnt(0)
    v_mfma_f32_32x32x16_bf16 v[32:47], v[160:163], v[176:179], v[32:47]
    ds_read_b128 v[184:187], v213 offset:49152
    ds_read_b128 v[188:191], v213 offset:53248
    s_waitcnt vmcnt(10)
    ds_read_b64_tr_b16 v[168:169], v208 offset:2048
    v_mfma_f32_32x32x16_bf16 v[48:63], v[160:163], v[180:183], v[48:63]
    ds_read_b64_tr_b16 v[170:171], v208 offset:2560
    ds_read_b64_tr_b16 v[172:173], v209 offset:2048
    ds_read_b64_tr_b16 v[174:175], v209 offset:2560
    v_mfma_f32_32x32x16_bf16 v[64:79], v[164:167], v[176:179], v[64:79]
    v_mfma_f32_32x32x16_bf16 v[80:95], v[164:167], v[180:183], v[80:95]
    s_waitcnt lgkmcnt(0)
    v_mfma_f32_32x32x16_bf16 v[32:47], v[168:171], v[184:187], v[32:47]
    ds_read_b128 v[176:179], v210 offset:57344
    ds_read_b128 v[180:183], v210 offset:61440
    s_waitcnt vmcnt(8)
    ds_read_b64_tr_b16 v[160:161], v204 offset:0
    v_mfma_f32_32x32x16_bf16 v[48:63], v[168:171], v[188:191], v[48:63]
    ds_read_b64_tr_b16 v[162:163], v204 offset:512
    ds_read_b64_tr_b16 v[164:165], v205 offset:0
    ds_read_b64_tr_b16 v[166:167], v205 offset:512
    v_mfma_f32_32x32x16_bf16 v[64:79], v[172:175], v[184:187], v[64:79]
    v_mfma_f32_32x32x16_bf16 v[80:95], v[172:175], v[188:191], v[80:95]
    s_waitcnt lgkmcnt(0)
    v_mfma_f32_32x32x16_bf16 v[32:47], v[160:163], v[176:179], v[32:47]
    ds_read_b128 v[184:187], v211 offset:57344
    ds_read_b128 v[188:191], v211 offset:61440
    s_waitcnt vmcnt(6)
    ds_read_b64_tr_b16 v[168:169], v204 offset:2048
    v_mfma_f32_32x32x16_bf16 v[48:63], v[160:163], v[180:183], v[48:63]
    ds_read_b64_tr_b16 v[170:171], v204 offset:2560
    ds_read_b64_tr_b16 v[172:173], v205 offset:2048
    ds_read_b64_tr_b16 v[174:175], v205 offset:2560
    s_add_u32 m0, s93, 0
    s_add_u32 s7, s28, 32768
    v_mfma_f32_32x32x16_bf16 v[64:79], v[164:167], v[176:179], v[64:79]
    buffer_load_dwordx4 v194, s[24:27], s7 offen lds
    buffer_load_dwordx4 v195, s[24:27], s7 offen offset:1024 lds
    v_mfma_f32_32x32x16_bf16 v[80:95], v[164:167], v[180:183], v[80:95]
    s_waitcnt lgkmcnt(0)
    v_mfma_f32_32x32x16_bf16 v[32:47], v[168:171], v[184:187], v[32:47]
    ds_read_b32 v7, v27 offset:0
    ds_read_b128 v[176:179], v212 offset:57344
    ds_read_b128 v[180:183], v212 offset:61440
    s_waitcnt vmcnt(6)
    ds_read_b64_tr_b16 v[160:161], v204 offset:4096
    v_mfma_f32_32x32x16_bf16 v[48:63], v[168:171], v[188:191], v[48:63]
    ds_read_b64_tr_b16 v[162:163], v204 offset:4608
    ds_read_b64_tr_b16 v[164:165], v205 offset:4096
    ds_read_b64_tr_b16 v[166:167], v205 offset:4608
    s_add_u32 m0, s93, 2048
    s_add_u32 s7, s28, 128
    v_mfma_f32_32x32x16_bf16 v[64:79], v[172:175], v[184:187], v[64:79]
    buffer_load_dwordx4 v194, s[24:27], s7 offen lds
    buffer_load_dwordx4 v195, s[24:27], s7 offen offset:1024 lds
    v_mfma_f32_32x32x16_bf16 v[80:95], v[172:175], v[188:191], v[80:95]
    s_waitcnt lgkmcnt(0)
    v_mfma_f32_32x32x16_bf16 v[32:47], v[160:163], v[176:179], v[32:47]
    v_cmp_gt_u32 vcc, 2, v7
    s_cbranch_vccz L40
    s_mov_b32 s92, 0x1000000
L41:
    ds_read_b32 v7, v27 offset:0
    s_sub_u32 s92, s92, 1
    s_cbranch_scc1 L42
    s_waitcnt lgkmcnt(0)
    v_cmp_gt_u32 vcc, 2, v7
    s_cbranch_vccnz L41
L42:
L40:
    ds_read_b128 v[184:187], v213 offset:57344
    ds_read_b128 v[188:191], v213 offset:61440
    s_waitcnt vmcnt(6)
    ds_read_b64_tr_b16 v[168:169], v204 offset:6144
    v_mfma_f32_32x32x16_bf16 v[48:63], v[160:163], v[180:183], v[48:63]
    ds_read_b64_tr_b16 v[170:171], v204 offset:6656
    ds_read_b64_tr_b16 v[172:173], v205 offset:6144
    ds_read_b64_tr_b16 v[174:175], v205 offset:6656
    s_add_u32 m0, s93, 4096
    s_add_u32 s7, s28, 32896
    v_mfma_f32_32x32x16_bf16 v[64:79], v[164:167], v[176:179], v[64:79]
    buffer_load_dwordx4 v194, s[24:27], s7 offen lds
    buffer_load_dwordx4 v195, s[24:27], s7 offen offset:1024 lds
    v_mfma_f32_32x32x16_bf16 v[80:95], v[164:167], v[180:183], v[80:95]
    s_waitcnt lgkmcnt(0)
    v_mfma_f32_32x32x16_bf16 v[64:79], v[172:175], v[184:187], v[64:79]
    v_mfma_f32_32x32x16_bf16 v[80:95], v[172:175], v[188:191], v[80:95]
    v_mfma_f32_32x32x16_bf16 v[32:47], v[168:171], v[184:187], v[32:47]
    v_mfma_f32_32x32x16_bf16 v[48:63], v[168:171], v[188:191], v[48:63]
    s_nop 8
    ds_write_b128 v4, v[64:67] offset:16384
    ds_write_b128 v6, v[68:71] offset:0
    ds_write_b128 v4, v[80:83] offset:17408
    ds_write_b128 v6, v[84:87] offset:1024
    ds_write_b128 v5, v[72:75] offset:16384
    ds_write_b128 v6, v[76:79] offset:2048
    ds_write_b128 v5, v[88:91] offset:17408
    ds_write_b128 v6, v[92:95] offset:3072
    v_mov_b32 v28, 4
    s_mov_b64 exec, 1
    ds_write_b32 v26, v28
    s_mov_b64 exec, -1
    ds_read_b32 v7, v27 offset:16
    s_load_dwordx2 s[48:49], s[36:37], 0
    v_mul_f32 v8, 0xbfb8aa3b, v32
    v_mul_f32 v9, 0xbfb8aa3b, v33
    v_mul_f32 v10, 0xbfb8aa3b, v34
    v_mul_f32 v11, 0xbfb8aa3b, v35
    v_mul_f32 v12, 0xbfb8aa3b, v36
    v_mul_f32 v13, 0xbfb8aa3b, v37
    v_mul_f32 v14, 0xbfb8aa3b, v38
    v_mul_f32 v15, 0xbfb8aa3b, v39
    v_exp_f32 v8, v8
    v_exp_f32 v9, v9
    v_exp_f32 v10, v10
    v_exp_f32 v11, v11
    v_exp_f32 v12, v12
    v_exp_f32 v13, v13
    v_exp_f32 v14, v14
    v_exp_f32 v15, v15
    v_add_f32 v8, 1.0, v8
    v_add_f32 v9, 1.0, v9
    v_add_f32 v10, 1.0, v10
    v_add_f32 v11, 1.0, v11
    v_add_f32 v12, 1.0, v12
    v_add_f32 v13, 1.0, v13
    v_add_f32 v14, 1.0, v14
    v_add_f32 v15, 1.0, v15
    v_rcp_f32 v8, v8
    v_rcp_f32 v9, v9
    v_rcp_f32 v10, v10
    v_rcp_f32 v11, v11
    v_rcp_f32 v12, v12
    v_rcp_f32 v13, v13
    v_rcp_f32 v14, v14
    v_rcp_f32 v15, v15
    v_mul_f32 v8, v8, v32
    v_mul_f32 v9, v9, v33
    v_mul_f32 v10, v10, v34
    v_mul_f32 v11, v11, v35
    v_mul_f32 v12, v12, v36
    v_mul_f32 v13, v13, v37
    v_mul_f32 v14, v14, v38
    v_mul_f32 v15, v15, v39
    v_cvt_pk_bf16_f32 v8, v8, v9
    v_cvt_pk_bf16_f32 v9, v10, v11
    v_cvt_pk_bf16_f32 v10, v12, v13
    v_cvt_pk_bf16_f32 v11, v14, v15
    ds_write_b128 v4, v[8:11] offset:0
    v_mul_f32 v16, 0xbfb8aa3b, v48
    v_mul_f32 v17, 0xbfb8aa3b, v49
    v_mul_f32 v18, 0xbfb8aa3b, v50
    v_mul_f32 v19, 0xbfb8aa3b, v51
    v_mul_f32 v20, 0xbfb8aa3b, v52
    v_mul_f32 v21, 0xbfb8aa3b, v53
    v_mul_f32 v22, 0xbfb8aa3b, v54
    v_mul_f32 v23, 0xbfb8aa3b, v55
    v_exp_f32 v16, v16
    v_exp_f32 v17, v17
    v_exp_f32 v18, v18
    v_exp_f32 v19, v19
    v_exp_f32 v20, v20
    v_exp_f32 v21, v21
    v_exp_f32 v22, v22
    v_exp_f32 v23, v23
    v_add_f32 v16, 1.0, v16
    v_add_f32 v17, 1.0, v17
    v_add_f32 v18, 1.0, v18
    v_add_f32 v19, 1.0, v19
    v_add_f32 v20, 1.0, v20
    v_add_f32 v21, 1.0, v21
    v_add_f32 v22, 1.0, v22
    v_add_f32 v23, 1.0, v23
    v_rcp_f32 v16, v16
    v_rcp_f32 v17, v17
    v_rcp_f32 v18, v18
    v_rcp_f32 v19, v19
    v_rcp_f32 v20, v20
    v_rcp_f32 v21, v21
    v_rcp_f32 v22, v22
    v_rcp_f32 v23, v23
    v_mul_f32 v16, v16, v48
    v_mul_f32 v17, v17, v49
    v_mul_f32 v18, v18, v50
    v_mul_f32 v19, v19, v51
    v_mul_f32 v20, v20, v52
    v_mul_f32 v21, v21, v53
    v_mul_f32 v22, v22, v54
    v_mul_f32 v23, v23, v55
    v_cvt_pk_bf16_f32 v16, v16, v17
    v_cvt_pk_bf16_f32 v17, v18, v19
    v_cvt_pk_bf16_f32 v18, v20, v21
    v_cvt_pk_bf16_f32 v19, v22, v23
    ds_write_b128 v4, v[16:19] offset:1024
    s_waitcnt lgkmcnt(0)
    v_cmp_gt_u32 vcc, 4, v7
    s_cbranch_vccz L43
    s_mov_b32 s92, 0x1000000
L44:
    ds_read_b32 v7, v27 offset:16
    s_sub_u32 s92, s92, 1
    s_cbranch_scc1 L45
    s_waitcnt lgkmcnt(0)
    v_cmp_gt_u32 vcc, 4, v7
    s_cbranch_vccnz L44
L45:
L43:
    s_cmp_lg_u32 s48, 0
    s_cbranch_scc1 L46
    s_mov_b32 s92, 400000
L47:
    s_load_dwordx2 s[48:49], s[36:37], 0 glc
    s_waitcnt lgkmcnt(0)
    s_cmp_lg_u32 s48, 0
    s_cbranch_scc1 L46
    s_sleep 2
    s_sub_u32 s92, s92, 1
    s_cbranch_scc0 L47
L46:
    v_mov_b32 v24, s48
    v_mov_b32 v25, s49
    s_lshl_b32 s94, s45, 14
    s_add_u32 m0, s93, 6144
    s_nop 0
    buffer_load_dwordx4 v194, s[24:27], s29 offen lds
    v_mul_f32 v8, 0xbfb8aa3b, v40
    v_mul_f32 v9, 0xbfb8aa3b, v41
    v_mul_f32 v10, 0xbfb8aa3b, v42
    v_mul_f32 v11, 0xbfb8aa3b, v43
    v_mul_f32 v12, 0xbfb8aa3b, v44
    v_mul_f32 v13, 0xbfb8aa3b, v45
    v_mul_f32 v14, 0xbfb8aa3b, v46
    v_mul_f32 v15, 0xbfb8aa3b, v47
    v_exp_f32 v8, v8
    v_exp_f32 v9, v9
    v_exp_f32 v10, v10
    buffer_load_dwordx4 v195, s[24:27], s29 offen offset:1024 lds
    v_exp_f32 v11, v11
    v_exp_f32 v12, v12
    v_exp_f32 v13, v13
    v_exp_f32 v14, v14
    v_exp_f32 v15, v15
    v_add_f32 v8, 1.0, v8
    v_add_f32 v9, 1.0, v9
    v_add_f32 v10, 1.0, v10
    v_add_f32 v11, 1.0, v11
    v_add_f32 v12, 1.0, v12
    v_add_f32 v13, 1.0, v13
    s_add_u32 m0, s94, 0
    s_add_u32 s7, s29, 32768
    buffer_load_dwordx4 v194, s[24:27], s7 offen lds
    v_add_f32 v14, 1.0, v14
    v_add_f32 v15, 1.0, v15
    v_rcp_f32 v8, v8
    v_rcp_f32 v9, v9
    v_rcp_f32 v10, v10
    v_rcp_f32 v11, v11
    v_rcp_f32 v12, v12
    v_rcp_f32 v13, v13
    v_rcp_f32 v14, v14
    v_rcp_f32 v15, v15
    v_mul_f32 v8, v8, v40
    buffer_load_dwordx4 v195, s[24:27], s7 offen offset:1024 lds
    v_mul_f32 v9, v9, v41
    v_mul_f32 v10, v10, v42
    v_mul_f32 v11, v11, v43
    v_mul_f32 v12, v12, v44
    v_mul_f32 v13, v13, v45
    v_mul_f32 v14, v14, v46
    v_mul_f32 v15, v15, v47
    v_cvt_pk_bf16_f32 v8, v8, v9
    v_cvt_pk_bf16_f32 v9, v10, v11
    v_cvt_pk_bf16_f32 v10, v12, v13
    v_cvt_pk_bf16_f32 v11, v14, v15
    s_add_u32 m0, s94, 2048
    s_add_u32 s7, s29, 128
    buffer_load_dwordx4 v194, s[24:27], s7 offen lds
    ds_write_b128 v5, v[8:11] offset:0
    v_mul_f32 v16, 0xbfb8aa3b, v56
    v_mul_f32 v17, 0xbfb8aa3b, v57
    v_mul_f32 v18, 0xbfb8aa3b, v58
    v_mul_f32 v19, 0xbfb8aa3b, v59
    v_mul_f32 v20, 0xbfb8aa3b, v60
    v_mul_f32 v21, 0xbfb8aa3b, v61
    v_mul_f32 v22, 0xbfb8aa3b, v62
    v_mul_f32 v23, 0xbfb8aa3b, v63
    v_exp_f32 v16, v16
    v_exp_f32 v17, v17
    buffer_load_dwordx4 v195, s[24:27], s7 offen offset:1024 lds
    v_exp_f32 v18, v18
    v_exp_f32 v19, v19
    v_exp_f32 v20, v20
    v_exp_f32 v21, v21
    v_exp_f32 v22, v22
    v_exp_f32 v23, v23
    v_add_f32 v16, 1.0, v16
    v_add_f32 v17, 1.0, v17
    v_add_f32 v18, 1.0, v18
    v_add_f32 v19, 1.0, v19
    v_add_f32 v20, 1.0, v20
    s_add_u32 m0, s94, 4096
    s_add_u32 s7, s29, 32896
    buffer_load_dwordx4 v194, s[24:27], s7 offen lds
    v_add_f32 v21, 1.0, v21
    v_add_f32 v22, 1.0, v22
    v_add_f32 v23, 1.0, v23
    v_rcp_f32 v16, v16
    v_rcp_f32 v17, v17
    v_rcp_f32 v18, v18
    v_rcp_f32 v19, v19
    v_rcp_f32 v20, v20
    v_rcp_f32 v21, v21
    v_rcp_f32 v22, v22
    v_rcp_f32 v23, v23
    buffer_load_dwordx4 v195, s[24:27], s7 offen offset:1024 lds
    v_mul_f32 v16, v16, v56
    v_mul_f32 v17, v17, v57
    v_mul_f32 v18, v18, v58
    v_mul_f32 v19, v19, v59
    v_mul_f32 v20, v20, v60
    v_mul_f32 v21, v21, v61
    v_mul_f32 v22, v22, v62
    v_mul_f32 v23, v23, v63
    v_cvt_pk_bf16_f32 v16, v16, v17
    v_cvt_pk_bf16_f32 v17, v18, v19
    v_cvt_pk_bf16_f32 v18, v20, v21
    v_cvt_pk_bf16_f32 v19, v22, v23
    ds_write_b128 v5, v[16:19] offset:1024
    v_mov_b32 v28, 5
    s_mov_b64 exec, 1
    ds_write_b32 v26, v28
    s_mov_b64 exec, -1
    s_add_u32 m0, s94, 6144
    s_nop 0
    buffer_load_dwordx4 v194, s[24:27], s30 offen lds
    buffer_load_dwordx4 v195, s[24:27], s30 offen offset:1024 lds
    s_add_u32 m0, s94, 8192
    s_nop 0
    buffer_load_dwordx4 v194, s[24:27], s31 offen lds
    buffer_load_dwordx4 v195, s[24:27], s31 offen offset:1024 lds
    s_mov_b32 s92, 0x1000000
L48:
    ds_read_b32 v28, v27 offset:16
    s_sub_u32 s92, s92, 1
    s_cbranch_scc1 L49
    s_waitcnt lgkmcnt(0)
    v_cmp_gt_u32 vcc, 5, v28
    s_cbranch_vccnz L48
L49:
    ds_read_b128 v[176:179], v198 offset:0
    ds_read_b128 v[180:183], v198 offset:1024
    s_waitcnt vmcnt(18)
    ds_read_b64_tr_b16 v[160:161], v204 offset:8192
    ds_read_b64_tr_b16 v[162:163], v204 offset:8704
    ds_read_b64_tr_b16 v[164:165], v205 offset:8192
    ds_read_b64_tr_b16 v[166:167], v205 offset:8704
    s_waitcnt lgkmcnt(0)
    v_mfma_f32_32x32x16_bf16 v[96:111], v[160:163], v[176:179], 0
    ds_read_b128 v[184:187], v198 offset:2048
    ds_read_b128 v[188:191], v198 offset:3072
    s_waitcnt vmcnt(10)
    ds_read_b64_tr_b16 v[168:169], v204 offset:6144
    v_mfma_f32_32x32x16_bf16 v[112:127], v[160:163], v[180:183], 0
    ds_read_b64_tr_b16 v[170:171], v204 offset:6656
    ds_read_b64_tr_b16 v[172:173], v205 offset:6144
    ds_read_b64_tr_b16 v[174:175], v205 offset:6656
    s_add_u32 m0, s93, 8192
    v_mfma_f32_32x32x16_bf16 v[128:143], v[164:167], v[176:179], 0
    buffer_load_dwordx4 v194, s[24:27], s32 offen lds
    buffer_load_dwordx4 v195, s[24:27], s32 offen offset:1024 lds
    v_mfma_f32_32x32x16_bf16 v[144:159], v[164:167], v[180:183], 0
    s_add_u32 m0, s94, 10240
    s_nop 0
    buffer_load_dwordx4 v194, s[24:27], s33 offen lds
    buffer_load_dwordx4 v195, s[24:27], s33 offen offset:1024 lds
    s_waitcnt lgkmcnt(0)
    v_mfma_f32_32x32x16_bf16 v[96:111], v[168:171], v[184:187], v[96:111]
    ds_read_b128 v[176:179], v198 offset:4096
    ds_read_b128 v[180:183], v198 offset:5120
    s_waitcnt vmcnt(6)
    ds_read_b64_tr_b16 v[160:161], v206 offset:6144
    v_mfma_f32_32x32x16_bf16 v[112:127], v[168:171], v[188:191], v[112:127]
    ds_read_b64_tr_b16 v[162:163], v206 offset:6656
    ds_read_b64_tr_b16 v[164:165], v207 offset:6144
    ds_read_b64_tr_b16 v[166:167], v207 offset:6656
    s_add_u32 m0, s94, 12288
    v_mfma_f32_32x32x16_bf16 v[128:143], v[172:175], v[184:187], v[128:143]
    buffer_load_dwordx4 v194, s[24:27], s34 offen lds
    buffer_load_dwordx4 v195, s[24:27], s34 offen offset:1024 lds
    v_mfma_f32_32x32x16_bf16 v[144:159], v[172:175], v[188:191], v[144:159]
    s_add_u32 m0, s94, 14336
    s_nop 0
    buffer_load_dwordx4 v194, s[24:27], s35 offen lds
    buffer_load_dwordx4 v195, s[24:27], s35 offen offset:1024 lds
    s_waitcnt lgkmcnt(0)
    v_mfma_f32_32x32x16_bf16 v[96:111], v[160:163], v[176:179], v[96:111]
    ds_read_b128 v[184:187], v198 offset:6144
    ds_read_b128 v[188:191], v198 offset:7168
    s_waitcnt vmcnt(8)
    ds_read_b64_tr_b16 v[168:169], v206 offset:8192
    v_mfma_f32_32x32x16_bf16 v[112:127], v[160:163], v[180:183], v[112:127]
    ds_read_b64_tr_b16 v[170:171], v206 offset:8704
    ds_read_b64_tr_b16 v[172:173], v207 offset:8192
    ds_read_b64_tr_b16 v[174:175], v207 offset:8704
    s_add_u32 m0, s93, 6144
    s_add_u32 s7, s30, 32768
    v_mfma_f32_32x32x16_bf16 v[128:143], v[164:167], v[176:179], v[128:143]
    buffer_load_dwordx4 v194, s[24:27], s7 offen lds
    buffer_load_dwordx4 v195, s[24:27], s7 offen offset:1024 lds
    v_mfma_f32_32x32x16_bf16 v[144:159], v[164:167], v[180:183], v[144:159]
    s_add_u32 m0, s94, 6144
    s_add_u32 s7, s31, 32768
    buffer_load_dwordx4 v194, s[24:27], s7 offen lds
    buffer_load_dwordx4 v195, s[24:27], s7 offen offset:1024 lds
    s_waitcnt lgkmcnt(0)
    v_mfma_f32_32x32x16_bf16 v[96:111], v[168:171], v[184:187], v[96:111]
    ds_read_b128 v[176:179], v198 offset:8192
    ds_read_b128 v[180:183], v198 offset:9216
    s_waitcnt vmcnt(10)
    ds_read_b64_tr_b16 v[160:161], v204 offset:8192
    v_mfma_f32_32x32x16_bf16 v[112:127], v[168:171], v[188:191], v[112:127]
    ds_read_b64_tr_b16 v[162:163], v204 offset:8704
    ds_read_b64_tr_b16 v[164:165], v205 offset:8192
    ds_read_b64_tr_b16 v[166:167], v205 offset:8704
    s_add_u32 m0, s94, 8192
    s_add_u32 s7, s32, 32768
    v_mfma_f32_32x32x16_bf16 v[128:143], v[172:175], v[184:187], v[128:143]
    buffer_load_dwordx4 v194, s[24:27], s7 offen lds
    buffer_load_dwordx4 v195, s[24:27], s7 offen offset:1024 lds
    v_mfma_f32_32x32x16_bf16 v[144:159], v[172:175], v[188:191], v[144:159]
    s_waitcnt lgkmcnt(0)
    v_mfma_f32_32x32x16_bf16 v[96:111], v[160:163], v[176:179], v[96:111]
    ds_read_b128 v[184:187], v198 offset:10240
    ds_read_b128 v[188:191], v198 offset:11264
    s_waitcnt vmcnt(10)
    ds_read_b64_tr_b16 v[168:169], v206 offset:10240
    v_mfma_f32_32x32x16_bf16 v[112:127], v[160:163], v[180:183], v[112:127]
    ds_read_b64_tr_b16 v[170:171], v206 offset:10752
    ds_read_b64_tr_b16 v[172:173], v207 offset:10240
    ds_read_b64_tr_b16 v[174:175], v207 offset:10752
    s_add_u32 m0, s93, 8192
    s_add_u32 s7, s33, 32768
    v_mfma_f32_32x32x16_bf16 v[128:143], v[164:167], v[176:179], v[128:143]
    buffer_load_dwordx4 v194, s[24:27], s7 offen lds
    buffer_load_dwordx4 v195, s[24:27], s7 offen offset:1024 lds
    v_mfma_f32_32x32x16_bf16 v[144:159], v[164:167], v[180:183], v[144:159]
    s_waitcnt lgkmcnt(0)
    v_mfma_f32_32x32x16_bf16 v[96:111], v[168:171], v[184:187], v[96:111]
    ds_read_b128 v[176:179], v198 offset:12288
    ds_read_b128 v[180:183], v198 offset:13312
    s_waitcnt vmcnt(10)
    ds_read_b64_tr_b16 v[160:161], v206 offset:12288
    v_mfma_f32_32x32x16_bf16 v[112:127], v[168:171], v[188:191], v[112:127]
    ds_read_b64_tr_b16 v[162:163], v206 offset:12800
    ds_read_b64_tr_b16 v[164:165], v207 offset:12288
    ds_read_b64_tr_b16 v[166:167], v207 offset:12800
    s_add_u32 m0, s94, 10240
    s_add_u32 s7, s34, 32768
    v_mfma_f32_32x32x16_bf16 v[128:143], v[172:175], v[184:187], v[128:143]
    buffer_load_dwordx4 v194, s[24:27], s7 offen lds
    buffer_load_dwordx4 v195, s[24:27], s7 offen offset:1024 lds
    v_mfma_f32_32x32x16_bf16 v[144:159], v[172:175], v[188:191], v[144:159]
    s_waitcnt lgkmcnt(0)
    v_mfma_f32_32x32x16_bf16 v[96:111], v[160:163], v[176:179], v[96:111]
    ds_read_b32 v7, v27 offset:0
    ds_read_b128 v[184:187], v198 offset:14336
    ds_read_b128 v[188:191], v198 offset:15360
    s_waitcnt vmcnt(10)
    ds_read_b64_tr_b16 v[168:169], v206 offset:14336
    v_mfma_f32_32x32x16_bf16 v[112:127], v[160:163], v[180:183], v[112:127]
    ds_read_b64_tr_b16 v[170:171], v206 offset:14848
    ds_read_b64_tr_b16 v[172:173], v207 offset:14336
    ds_read_b64_tr_b16 v[174:175], v207 offset:14848
    s_add_u32 m0, s94, 12288
    s_add_u32 s7, s35, 32768
    v_mfma_f32_32x32x16_bf16 v[128:143], v[164:167], v[176:179], v[128:143]
    buffer_load_dwordx4 v194, s[24:27], s7 offen lds
    buffer_load_dwordx4 v195, s[24:27], s7 offen offset:1024 lds
    v_mfma_f32_32x32x16_bf16 v[144:159], v[164:167], v[180:183], v[144:159]
    s_waitcnt lgkmcnt(0)
    v_mfma_f32_32x32x16_bf16 v[96:111], v[168:171], v[184:187], v[96:111]
    v_cmp_gt_u32 vcc, 3, v7
    s_cbranch_vccz L50
    s_mov_b32 s92, 0x1000000
L51:
    ds_read_b32 v7, v27 offset:0
    s_sub_u32 s92, s92, 1
    s_cbranch_scc1 L52
    s_waitcnt lgkmcnt(0)
    v_cmp_gt_u32 vcc, 3, v7
    s_cbranch_vccnz L51
L52:
L50:
    ds_read_b128 v[176:179], v198 offset:16384
    ds_read_b128 v[180:183], v198 offset:17408
    ds_read_b64_tr_b16 v[160:161], v204 offset:0
    v_mfma_f32_32x32x16_bf16 v[112:127], v[168:171], v[188:191], v[112:127]
    ds_read_b64_tr_b16 v[162:163], v204 offset:512
    ds_read_b64_tr_b16 v[164:165], v205 offset:0
    ds_read_b64_tr_b16 v[166:167], v205 offset:512
    s_add_u32 m0, s94, 14336
    s_add_u32 s7, s30, 128
    v_mfma_f32_32x32x16_bf16 v[128:143], v[172:175], v[184:187], v[128:143]
    buffer_load_dwordx4 v194, s[24:27], s7 offen lds
    buffer_load_dwordx4 v195, s[24:27], s7 offen offset:1024 lds
    v_mfma_f32_32x32x16_bf16 v[144:159], v[172:175], v[188:191], v[144:159]
    s_waitcnt lgkmcnt(0)
    v_mfma_f32_32x32x16_bf16 v[96:111], v[160:163], v[176:179], v[96:111]
    ds_read_b128 v[184:187], v198 offset:18432
    ds_read_b128 v[188:191], v198 offset:19456
    ds_read_b64_tr_b16 v[168:169], v206 offset:0
    v_mfma_f32_32x32x16_bf16 v[112:127], v[160:163], v[180:183], v[112:127]
    ds_read_b64_tr_b16 v[170:171], v206 offset:512
    ds_read_b64_tr_b16 v[172:173], v207 offset:0
    ds_read_b64_tr_b16 v[174:175], v207 offset:512
    s_add_u32 m0, s93, 0
    s_add_u32 s7, s31, 128
    v_mfma_f32_32x32x16_bf16 v[128:143], v[164:167], v[176:179], v[128:143]
    buffer_load_dwordx4 v194, s[24:27], s7 offen lds
    buffer_load_dwordx4 v195, s[24:27], s7 offen offset:1024 lds
    v_mfma_f32_32x32x16_bf16 v[144:159], v[164:167], v[180:183], v[144:159]
    s_waitcnt lgkmcnt(0)
    v_mfma_f32_32x32x16_bf16 v[96:111], v[168:171], v[184:187], v[96:111]
    ds_read_b128 v[176:179], v198 offset:20480
    ds_read_b128 v[180:183], v198 offset:21504
    s_waitcnt vmcnt(14)
    ds_read_b64_tr_b16 v[160:161], v204 offset:6144
    v_mfma_f32_32x32x16_bf16 v[112:127], v[168:171], v[188:191], v[112:127]
    ds_read_b64_tr_b16 v[162:163], v204 offset:6656
    ds_read_b64_tr_b16 v[164:165], v205 offset:6144
    ds_read_b64_tr_b16 v[166:167], v205 offset:6656
    s_add_u32 m0, s94, 0
    s_add_u32 s7, s32, 128
    v_mfma_f32_32x32x16_bf16 v[128:143], v[172:175], v[184:187], v[128:143]
    buffer_load_dwordx4 v194, s[24:27], s7 offen lds
    buffer_load_dwordx4 v195, s[24:27], s7 offen offset:1024 lds
    v_mfma_f32_32x32x16_bf16 v[144:159], v[172:175], v[188:191], v[144:159]
    s_waitcnt lgkmcnt(0)
    v_mfma_f32_32x32x16_bf16 v[96:111], v[160:163], v[176:179], v[96:111]
    ds_read_b128 v[184:187], v198 offset:22528
    ds_read_b128 v[188:191], v198 offset:23552
    s_waitcnt vmcnt(14)
    ds_read_b64_tr_b16 v[168:169], v206 offset:6144
    v_mfma_f32_32x32x16_bf16 v[112:127], v[160:163], v[180:183], v[112:127]
    ds_read_b64_tr_b16 v[170:171], v206 offset:6656
    ds_read_b64_tr_b16 v[172:173], v207 offset:6144
    ds_read_b64_tr_b16 v[174:175], v207 offset:6656
    s_add_u32 m0, s93, 6144
    s_add_u32 s7, s33, 128
    v_mfma_f32_32x32x16_bf16 v[128:143], v[164:167], v[176:179], v[128:143]
    buffer_load_dwordx4 v194, s[24:27], s7 offen lds
    buffer_load_dwordx4 v195, s[24:27], s7 offen offset:1024 lds
    v_mfma_f32_32x32x16_bf16 v[144:159], v[164:167], v[180:183], v[144:159]
    s_waitcnt lgkmcnt(0)
    v_mfma_f32_32x32x16_bf16 v[96:111], v[168:171], v[184:187], v[96:111]
    ds_read_b128 v[176:179], v198 offset:24576
    ds_read_b128 v[180:183], v198 offset:25600
    s_waitcnt vmcnt(14)
    ds_read_b64_tr_b16 v[160:161], v206 offset:8192
    v_mfma_f32_32x32x16_bf16 v[112:127], v[168:171], v[188:191], v[112:127]
    ds_read_b64_tr_b16 v[162:163], v206 offset:8704
    ds_read_b64_tr_b16 v[164:165], v207 offset:8192
    ds_read_b64_tr_b16 v[166:167], v207 offset:8704
    s_add_u32 m0, s94, 6144
    s_add_u32 s7, s34, 128
    v_mfma_f32_32x32x16_bf16 v[128:143], v[172:175], v[184:187], v[128:143]
    buffer_load_dwordx4 v194, s[24:27], s7 offen lds
    buffer_load_dwordx4 v195, s[24:27], s7 offen offset:1024 lds
    v_mfma_f32_32x32x16_bf16 v[144:159], v[172:175], v[188:191], v[144:159]
    s_waitcnt lgkmcnt(0)
    v_mfma_f32_32x32x16_bf16 v[96:111], v[160:163], v[176:179], v[96:111]
    ds_read_b128 v[184:187], v198 offset:26624
    ds_read_b128 v[188:191], v198 offset:27648
    s_waitcnt vmcnt(14)
    ds_read_b64_tr_b16 v[168:169], v204 offset:8192
    v_mfma_f32_32x32x16_bf16 v[112:127], v[160:163], v[180:183], v[112:127]
    ds_read_b64_tr_b16 v[170:171], v204 offset:8704
    ds_read_b64_tr_b16 v[172:173], v205 offset:8192
    ds_read_b64_tr_b16 v[174:175], v205 offset:8704
    s_add_u32 m0, s94, 8192
    s_add_u32 s7, s35, 128
    v_mfma_f32_32x32x16_bf16 v[128:143], v[164:167], v[176:179], v[128:143]
    buffer_load_dwordx4 v194, s[24:27], s7 offen lds
    buffer_load_dwordx4 v195, s[24:27], s7 offen offset:1024 lds
    v_mfma_f32_32x32x16_bf16 v[144:159], v[164:167], v[180:183], v[144:159]
    s_waitcnt lgkmcnt(0)
    v_mfma_f32_32x32x16_bf16 v[96:111], v[168:171], v[184:187], v[96:111]
    ds_read_b128 v[176:179], v198 offset:28672
    ds_read_b128 v[180:183], v198 offset:29696
    s_waitcnt vmcnt(14)
    ds_read_b64_tr_b16 v[160:161], v206 offset:10240
    v_mfma_f32_32x32x16_bf16 v[112:127], v[168:171], v[188:191], v[112:127]
    ds_read_b64_tr_b16 v[162:163], v206 offset:10752
    ds_read_b64_tr_b16 v[164:165], v207 offset:10240
    ds_read_b64_tr_b16 v[166:167], v207 offset:10752
    v_mfma_f32_32x32x16_bf16 v[128:143], v[172:175], v[184:187], v[128:143]
    v_mfma_f32_32x32x16_bf16 v[144:159], v[172:175], v[188:191], v[144:159]
    s_waitcnt lgkmcnt(0)
    v_mfma_f32_32x32x16_bf16 v[96:111], v[160:163], v[176:179], v[96:111]
    ds_read_b128 v[184:187], v198 offset:30720
    ds_read_b128 v[188:191], v198 offset:31744
    s_waitcnt vmcnt(12)
    ds_read_b64_tr_b16 v[168:169], v206 offset:12288
    v_mfma_f32_32x32x16_bf16 v[112:127], v[160:163], v[180:183], v[112:127]
    ds_read_b64_tr_b16 v[170:171], v206 offset:12800
    ds_read_b64_tr_b16 v[172:173], v207 offset:12288
    ds_read_b64_tr_b16 v[174:175], v207 offset:12800
    s_add_u32 m0, s94, 10240
    s_add_u32 s7, s30, 32896
    v_mfma_f32_32x32x16_bf16 v[128:143], v[164:167], v[176:179], v[128:143]
    buffer_load_dwordx4 v194, s[24:27], s7 offen lds
    buffer_load_dwordx4 v195, s[24:27], s7 offen offset:1024 lds
    v_mfma_f32_32x32x16_bf16 v[144:159], v[164:167], v[180:183], v[144:159]
    s_waitcnt lgkmcnt(0)
    v_mfma_f32_32x32x16_bf16 v[96:111], v[168:171], v[184:187], v[96:111]
    ds_read_b128 v[176:179], v198 offset:0
    ds_read_b128 v[180:183], v198 offset:1024
    ds_read_b64_tr_b16 v[160:161], v204 offset:2048
    v_mfma_f32_32x32x16_bf16 v[112:127], v[168:171], v[188:191], v[112:127]
    ds_read_b64_tr_b16 v[162:163], v204 offset:2560
    ds_read_b64_tr_b16 v[164:165], v205 offset:2048
    ds_read_b64_tr_b16 v[166:167], v205 offset:2560
    s_add_u32 m0, s94, 12288
    s_add_u32 s7, s31, 32896
    v_mfma_f32_32x32x16_bf16 v[128:143], v[172:175], v[184:187], v[128:143]
    buffer_load_dwordx4 v194, s[24:27], s7 offen lds
    buffer_load_dwordx4 v195, s[24:27], s7 offen offset:1024 lds
    v_mfma_f32_32x32x16_bf16 v[144:159], v[172:175], v[188:191], v[144:159]
    s_waitcnt lgkmcnt(0)
    v_mfma_f32_32x32x16_bf16 v[32:47], v[160:163], v[176:179], 0
    ds_read_b128 v[184:187], v198 offset:2048
    ds_read_b128 v[188:191], v198 offset:3072
    ds_read_b64_tr_b16 v[168:169], v206 offset:2048
    v_mfma_f32_32x32x16_bf16 v[48:63], v[160:163], v[180:183], 0
    ds_read_b64_tr_b16 v[170:171], v206 offset:2560
    ds_read_b64_tr_b16 v[172:173], v207 offset:2048
    ds_read_b64_tr_b16 v[174:175], v207 offset:2560
    s_add_u32 m0, s93, 2048
    s_add_u32 s7, s32, 32896
    v_mfma_f32_32x32x16_bf16 v[64:79], v[164:167], v[176:179], 0
    buffer_load_dwordx4 v194, s[24:27], s7 offen lds
    buffer_load_dwordx4 v195, s[24:27], s7 offen offset:1024 lds
    v_mfma_f32_32x32x16_bf16 v[80:95], v[164:167], v[180:183], 0
    s_waitcnt lgkmcnt(0)
    v_mfma_f32_32x32x16_bf16 v[32:47], v[168:171], v[184:187], v[32:47]
    ds_read_b128 v[176:179], v198 offset:4096
    ds_read_b128 v[180:183], v198 offset:5120
    s_waitcnt vmcnt(16)
    ds_read_b64_tr_b16 v[160:161], v206 offset:14336
    v_mfma_f32_32x32x16_bf16 v[48:63], v[168:171], v[188:191], v[48:63]
    ds_read_b64_tr_b16 v[162:163], v206 offset:14848
    ds_read_b64_tr_b16 v[164:165], v207 offset:14336
    ds_read_b64_tr_b16 v[166:167], v207 offset:14848
    s_add_u32 m0, s94, 2048
    s_add_u32 s7, s33, 32896
    v_mfma_f32_32x32x16_bf16 v[64:79], v[172:175], v[184:187], v[64:79]
    buffer_load_dwordx4 v194, s[24:27], s7 offen lds
    buffer_load_dwordx4 v195, s[24:27], s7 offen offset:1024 lds
    v_mfma_f32_32x32x16_bf16 v[80:95], v[172:175], v[188:191], v[80:95]
    s_waitcnt lgkmcnt(0)
    v_mfma_f32_32x32x16_bf16 v[32:47], v[160:163], v[176:179], v[32:47]
    ds_read_b128 v[184:187], v198 offset:6144
    ds_read_b128 v[188:191], v198 offset:7168
    s_waitcnt vmcnt(16)
    ds_read_b64_tr_b16 v[168:169], v204 offset:0
    v_mfma_f32_32x32x16_bf16 v[48:63], v[160:163], v[180:183], v[48:63]
    ds_read_b64_tr_b16 v[170:171], v204 offset:512
    ds_read_b64_tr_b16 v[172:173], v205 offset:0
    ds_read_b64_tr_b16 v[174:175], v205 offset:512
    s_add_u32 m0, s94, 14336
    s_add_u32 s7, s34, 32896
    v_mfma_f32_32x32x16_bf16 v[64:79], v[164:167], v[176:179], v[64:79]
    buffer_load_dwordx4 v194, s[24:27], s7 offen lds
    buffer_load_dwordx4 v195, s[24:27], s7 offen offset:1024 lds
    v_mfma_f32_32x32x16_bf16 v[80:95], v[164:167], v[180:183], v[80:95]
    s_waitcnt lgkmcnt(0)
    v_mfma_f32_32x32x16_bf16 v[32:47], v[168:171], v[184:187], v[32:47]
    ds_read_b128 v[176:179], v198 offset:8192
    ds_read_b128 v[180:183], v198 offset:9216
    s_waitcnt vmcnt(16)
    ds_read_b64_tr_b16 v[160:161], v206 offset:0
    v_mfma_f32_32x32x16_bf16 v[48:63], v[168:171], v[188:191], v[48:63]
    ds_read_b64_tr_b16 v[162:163], v206 offset:512
    ds_read_b64_tr_b16 v[164:165], v207 offset:0
    ds_read_b64_tr_b16 v[166:167], v207 offset:512
    s_add_u32 m0, s93, 0
    s_add_u32 s7, s35, 32896
    v_mfma_f32_32x32x16_bf16 v[64:79], v[172:175], v[184:187], v[64:79]
    buffer_load_dwordx4 v194, s[24:27], s7 offen lds
    buffer_load_dwordx4 v195, s[24:27], s7 offen offset:1024 lds
    s_add_u32 s6, s95, 0
    v_cvt_pk_bf16_f32 v8, v96, v97
    v_cvt_pk_bf16_f32 v9, v98, v99
    v_cvt_pk_bf16_f32 v10, v100, v101
    v_cvt_pk_bf16_f32 v11, v102, v103
    buffer_store_dwordx4 v[8:11], v199, s[40:43], s6 offen offset:0 sc1
    v_mfma_f32_32x32x16_bf16 v[80:95], v[172:175], v[188:191], v[80:95]
    v_cvt_pk_bf16_f32 v12, v104, v105
    v_cvt_pk_bf16_f32 v13, v106, v107
    v_cvt_pk_bf16_f32 v14, v108, v109
    v_cvt_pk_bf16_f32 v15, v110, v111
    buffer_store_dwordx4 v[12:15], v199, s[40:43], s6 offen offset:256 sc1
    s_waitcnt lgkmcnt(0)
    v_mfma_f32_32x32x16_bf16 v[32:47], v[160:163], v[176:179], v[32:47]
    ds_read_b128 v[184:187], v198 offset:10240
    ds_read_b128 v[188:191], v198 offset:11264
    s_waitcnt vmcnt(18)
    ds_read_b64_tr_b16 v[168:169], v204 offset:6144
    v_mfma_f32_32x32x16_bf16 v[48:63], v[160:163], v[180:183], v[48:63]
    ds_read_b64_tr_b16 v[170:171], v204 offset:6656
    ds_read_b64_tr_b16 v[172:173], v205 offset:6144
    ds_read_b64_tr_b16 v[174:175], v205 offset:6656
    v_mfma_f32_32x32x16_bf16 v[64:79], v[164:167], v[176:179], v[64:79]
    v_cvt_pk_bf16_f32 v16, v128, v129
    v_cvt_pk_bf16_f32 v17, v130, v131
    v_cvt_pk_bf16_f32 v18, v132, v133
    v_cvt_pk_bf16_f32 v19, v134, v135
    buffer_store_dwordx4 v[16:19], v199, s[40:43], s6 offen offset:512 sc1
    v_cvt_pk_bf16_f32 v20, v136, v137
    v_mfma_f32_32x32x16_bf16 v[80:95], v[164:167], v[180:183], v[80:95]
    v_cvt_pk_bf16_f32 v21, v138, v139
    v_cvt_pk_bf16_f32 v22, v140, v141
    v_cvt_pk_bf16_f32 v23, v142, v143
    buffer_store_dwordx4 v[20:23], v199, s[40:43], s6 offen offset:768 sc1
    s_mov_b64 exec, s[50:51]
    ds_write_b128 v201, v[8:11] offset:0
    ds_write_b128 v201, v[12:15] offset:256
    ds_write_b128 v201, v[16:19] offset:512
    ds_write_b128 v201, v[20:23] offset:768
    s_mov_b64 exec, -1
    s_waitcnt lgkmcnt(4)
    v_mfma_f32_32x32x16_bf16 v[32:47], v[168:171], v[184:187], v[32:47]
    ds_read_b128 v[176:179], v198 offset:12288
    ds_read_b128 v[180:183], v198 offset:13312
    s_waitcnt vmcnt(18)
    ds_read_b64_tr_b16 v[160:161], v206 offset:6144
    v_mfma_f32_32x32x16_bf16 v[48:63], v[168:171], v[188:191], v[48:63]
    ds_read_b64_tr_b16 v[162:163], v206 offset:6656
    ds_read_b64_tr_b16 v[164:165], v207 offset:6144
    ds_read_b64_tr_b16 v[166:167], v207 offset:6656
    v_mfma_f32_32x32x16_bf16 v[64:79], v[172:175], v[184:187], v[64:79]
    s_add_u32 s6, s95, 262144
    v_cvt_pk_bf16_f32 v8, v112, v113
    v_cvt_pk_bf16_f32 v9, v114, v115
    v_cvt_pk_bf16_f32 v10, v116, v117
    v_cvt_pk_bf16_f32 v11, v118, v119
    buffer_store_dwordx4 v[8:11], v200, s[40:43], s6 offen offset:0 sc1
    v_mfma_f32_32x32x16_bf16 v[80:95], v[172:175], v[188:191], v[80:95]
    v_cvt_pk_bf16_f32 v12, v120, v121
    v_cvt_pk_bf16_f32 v13, v122, v123
    v_cvt_pk_bf16_f32 v14, v124, v125
    v_cvt_pk_bf16_f32 v15, v126, v127
    buffer_store_dwordx4 v[12:15], v200, s[40:43], s6 offen offset:256 sc1
    s_waitcnt lgkmcnt(0)
    v_mfma_f32_32x32x16_bf16 v[32:47], v[160:163], v[176:179], v[32:47]
    ds_read_b128 v[184:187], v198 offset:14336
    ds_read_b128 v[188:191], v198 offset:15360
    s_waitcnt vmcnt(18)
    ds_read_b64_tr_b16 v[168:169], v206 offset:8192
    v_mfma_f32_32x32x16_bf16 v[48:63], v[160:163], v[180:183], v[48:63]
    ds_read_b64_tr_b16 v[170:171], v206 offset:8704
    ds_read_b64_tr_b16 v[172:173], v207 offset:8192
    ds_read_b64_tr_b16 v[174:175], v207 offset:8704
    v_mfma_f32_32x32x16_bf16 v[64:79], v[164:167], v[176:179], v[64:79]
    v_cvt_pk_bf16_f32 v16, v144, v145
    v_cvt_pk_bf16_f32 v17, v146, v147
    v_cvt_pk_bf16_f32 v18, v148, v149
    v_cvt_pk_bf16_f32 v19, v150, v151
    buffer_store_dwordx4 v[16:19], v200, s[40:43], s6 offen offset:512 sc1
    v_cvt_pk_bf16_f32 v20, v152, v153
    v_mfma_f32_32x32x16_bf16 v[80:95], v[164:167], v[180:183], v[80:95]
    v_cvt_pk_bf16_f32 v21, v154, v155
    v_cvt_pk_bf16_f32 v22, v156, v157
    v_cvt_pk_bf16_f32 v23, v158, v159
    buffer_store_dwordx4 v[20:23], v200, s[40:43], s6 offen offset:768 sc1
    s_mov_b64 exec, s[52:53]
    ds_write_b128 v201, v[8:11] offset:0
    ds_write_b128 v201, v[12:15] offset:256
    ds_write_b128 v201, v[16:19] offset:512
    ds_write_b128 v201, v[20:23] offset:768
    s_mov_b64 exec, -1
    s_waitcnt lgkmcnt(4)
    v_mfma_f32_32x32x16_bf16 v[32:47], v[168:171], v[184:187], v[32:47]
    ds_read_b128 v[176:179], v198 offset:16384
    ds_read_b128 v[180:183], v198 offset:17408
    ds_read_b64_tr_b16 v[160:161], v204 offset:4096
    v_mfma_f32_32x32x16_bf16 v[48:63], v[168:171], v[188:191], v[48:63]
    ds_read_b64_tr_b16 v[162:163], v204 offset:4608
    ds_read_b64_tr_b16 v[164:165], v205 offset:4096
    ds_read_b64_tr_b16 v[166:167], v205 offset:4608
    v_mfma_f32_32x32x16_bf16 v[64:79], v[172:175], v[184:187], v[64:79]
    v_mfma_f32_32x32x16_bf16 v[80:95], v[172:175], v[188:191], v[80:95]
    s_waitcnt lgkmcnt(0)
    v_mfma_f32_32x32x16_bf16 v[32:47], v[160:163], v[176:179], v[32:47]
    ds_read_b128 v[184:187], v198 offset:18432
    ds_read_b128 v[188:191], v198 offset:19456
    ds_read_b64_tr_b16 v[168:169], v206 offset:4096
    v_mfma_f32_32x32x16_bf16 v[48:63], v[160:163], v[180:183], v[48:63]
    ds_read_b64_tr_b16 v[170:171], v206 offset:4608
    ds_read_b64_tr_b16 v[172:173], v207 offset:4096
    ds_read_b64_tr_b16 v[174:175], v207 offset:4608
    v_mfma_f32_32x32x16_bf16 v[64:79], v[164:167], v[176:179], v[64:79]
    v_mfma_f32_32x32x16_bf16 v[80:95], v[164:167], v[180:183], v[80:95]
    s_waitcnt lgkmcnt(0)
    v_mfma_f32_32x32x16_bf16 v[32:47], v[168:171], v[184:187], v[32:47]
    ds_read_b128 v[176:179], v198 offset:20480
    ds_read_b128 v[180:183], v198 offset:21504
    s_waitcnt vmcnt(18)
    ds_read_b64_tr_b16 v[160:161], v206 offset:10240
    v_mfma_f32_32x32x16_bf16 v[48:63], v[168:171], v[188:191], v[48:63]
    ds_read_b64_tr_b16 v[162:163], v206 offset:10752
    ds_read_b64_tr_b16 v[164:165], v207 offset:10240
    ds_read_b64_tr_b16 v[166:167], v207 offset:10752
    v_mfma_f32_32x32x16_bf16 v[64:79], v[172:175], v[184:187], v[64:79]
    v_mfma_f32_32x32x16_bf16 v[80:95], v[172:175], v[188:191], v[80:95]
    s_waitcnt lgkmcnt(0)
    v_mfma_f32_32x32x16_bf16 v[32:47], v[160:163], v[176:179], v[32:47]
    ds_read_b128 v[184:187], v198 offset:22528
    ds_read_b128 v[188:191], v198 offset:23552
    s_waitcnt vmcnt(16)
    ds_read_b64_tr_b16 v[168:169], v206 offset:12288
    v_mfma_f32_32x32x16_bf16 v[48:63], v[160:163], v[180:183], v[48:63]
    ds_read_b64_tr_b16 v[170:171], v206 offset:12800
    ds_read_b64_tr_b16 v[172:173], v207 offset:12288
    ds_read_b64_tr_b16 v[174:175], v207 offset:12800
    v_mfma_f32_32x32x16_bf16 v[64:79], v[164:167], v[176:179], v[64:79]
    v_mfma_f32_32x32x16_bf16 v[80:95], v[164:167], v[180:183], v[80:95]
    s_waitcnt lgkmcnt(0)
    v_mfma_f32_32x32x16_bf16 v[32:47], v[168:171], v[184:187], v[32:47]
    ds_read_b128 v[176:179], v198 offset:24576
    ds_read_b128 v[180:183], v198 offset:25600
    s_waitcnt vmcnt(14)
    ds_read_b64_tr_b16 v[160:161], v204 offset:2048
    v_mfma_f32_32x32x16_bf16 v[48:63], v[168:171], v[188:191], v[48:63]
    ds_read_b64_tr_b16 v[162:163], v204 offset:2560
    ds_read_b64_tr_b16 v[164:165], v205 offset:2048
    ds_read_b64_tr_b16 v[166:167], v205 offset:2560
    v_mfma_f32_32x32x16_bf16 v[64:79], v[172:175], v[184:187], v[64:79]
    v_mfma_f32_32x32x16_bf16 v[80:95], v[172:175], v[188:191], v[80:95]
    s_waitcnt lgkmcnt(0)
    v_mfma_f32_32x32x16_bf16 v[32:47], v[160:163], v[176:179], v[32:47]
    ds_read_b128 v[184:187], v198 offset:26624
    ds_read_b128 v[188:191], v198 offset:27648
    s_waitcnt vmcnt(12)
    ds_read_b64_tr_b16 v[168:169], v206 offset:2048
    v_mfma_f32_32x32x16_bf16 v[48:63], v[160:163], v[180:183], v[48:63]
    ds_read_b64_tr_b16 v[170:171], v206 offset:2560
    ds_read_b64_tr_b16 v[172:173], v207 offset:2048
    ds_read_b64_tr_b16 v[174:175], v207 offset:2560
    v_mfma_f32_32x32x16_bf16 v[64:79], v[164:167], v[176:179], v[64:79]
    v_mfma_f32_32x32x16_bf16 v[80:95], v[164:167], v[180:183], v[80:95]
    s_waitcnt lgkmcnt(0)
    v_mfma_f32_32x32x16_bf16 v[32:47], v[168:171], v[184:187], v[32:47]
    ds_read_b128 v[176:179], v198 offset:28672
    ds_read_b128 v[180:183], v198 offset:29696
    s_waitcnt vmcnt(10)
    ds_read_b64_tr_b16 v[160:161], v206 offset:14336
    v_mfma_f32_32x32x16_bf16 v[48:63], v[168:171], v[188:191], v[48:63]
    ds_read_b64_tr_b16 v[162:163], v206 offset:14848
    ds_read_b64_tr_b16 v[164:165], v207 offset:14336
    ds_read_b64_tr_b16 v[166:167], v207 offset:14848
    v_mfma_f32_32x32x16_bf16 v[64:79], v[172:175], v[184:187], v[64:79]
    v_mfma_f32_32x32x16_bf16 v[80:95], v[172:175], v[188:191], v[80:95]
    s_waitcnt lgkmcnt(0)
    v_mfma_f32_32x32x16_bf16 v[32:47], v[160:163], v[176:179], v[32:47]
    ds_read_b128 v[184:187], v198 offset:30720
    ds_read_b128 v[188:191], v198 offset:31744
    s_waitcnt vmcnt(8)
    ds_read_b64_tr_b16 v[168:169], v204 offset:0
    v_mfma_f32_32x32x16_bf16 v[48:63], v[160:163], v[180:183], v[48:63]
    ds_read_b64_tr_b16 v[170:171], v204 offset:512
    ds_read_b64_tr_b16 v[172:173], v205 offset:0
    ds_read_b64_tr_b16 v[174:175], v205 offset:512
    v_mfma_f32_32x32x16_bf16 v[64:79], v[164:167], v[176:179], v[64:79]
    v_mfma_f32_32x32x16_bf16 v[80:95], v[164:167], v[180:183], v[80:95]
    s_waitcnt lgkmcnt(0)
    v_mfma_f32_32x32x16_bf16 v[32:47], v[168:171], v[184:187], v[32:47]
    v_mfma_f32_32x32x16_bf16 v[48:63], v[168:171], v[188:191], v[48:63]
    v_mfma_f32_32x32x16_bf16 v[64:79], v[172:175], v[184:187], v[64:79]
    s_waitcnt vmcnt(0)
    s_mov_b64 exec, 0xff
    buffer_store_dwordx2 v[24:25], v202, s[40:43], s96 offen offset:0 sc1
    s_mov_b64 exec, -1
    v_mfma_f32_32x32x16_bf16 v[80:95], v[172:175], v[188:191], v[80:95]
    s_add_u32 s6, s95, 4096
    s_nop 3
    v_cvt_pk_bf16_f32 v8, v32, v33
    v_cvt_pk_bf16_f32 v9, v34, v35
    v_cvt_pk_bf16_f32 v10, v36, v37
    v_cvt_pk_bf16_f32 v11, v38, v39
    buffer_store_dwordx4 v[8:11], v199, s[40:43], s6 offen offset:0 sc1
    v_cvt_pk_bf16_f32 v12, v40, v41
    v_cvt_pk_bf16_f32 v13, v42, v43
    v_cvt_pk_bf16_f32 v14, v44, v45
    v_cvt_pk_bf16_f32 v15, v46, v47
    buffer_store_dwordx4 v[12:15], v199, s[40:43], s6 offen offset:256 sc1
    v_cvt_pk_bf16_f32 v16, v64, v65
    v_cvt_pk_bf16_f32 v17, v66, v67
    v_cvt_pk_bf16_f32 v18, v68, v69
    v_cvt_pk_bf16_f32 v19, v70, v71
    buffer_store_dwordx4 v[16:19], v199, s[40:43], s6 offen offset:512 sc1
    v_cvt_pk_bf16_f32 v20, v72, v73
    v_cvt_pk_bf16_f32 v21, v74, v75
    v_cvt_pk_bf16_f32 v22, v76, v77
    v_cvt_pk_bf16_f32 v23, v78, v79
    buffer_store_dwordx4 v[20:23], v199, s[40:43], s6 offen offset:768 sc1
    s_mov_b64 exec, s[50:51]
    ds_write_b128 v201, v[8:11] offset:1024
    ds_write_b128 v201, v[12:15] offset:1280
    ds_write_b128 v201, v[16:19] offset:1536
    ds_write_b128 v201, v[20:23] offset:1792
    s_mov_b64 exec, -1
    s_add_u32 s6, s95, 266240
    v_cvt_pk_bf16_f32 v8, v48, v49
    v_cvt_pk_bf16_f32 v9, v50, v51
    v_cvt_pk_bf16_f32 v10, v52, v53
    v_cvt_pk_bf16_f32 v11, v54, v55
    buffer_store_dwordx4 v[8:11], v200, s[40:43], s6 offen offset:0 sc1
    v_cvt_pk_bf16_f32 v12, v56, v57
    v_cvt_pk_bf16_f32 v13, v58, v59
    v_cvt_pk_bf16_f32 v14, v60, v61
    v_cvt_pk_bf16_f32 v15, v62, v63
    buffer_store_dwordx4 v[12:15], v200, s[40:43], s6 offen offset:256 sc1
    v_cvt_pk_bf16_f32 v16, v80, v81
    v_cvt_pk_bf16_f32 v17, v82, v83
    v_cvt_pk_bf16_f32 v18, v84, v85
    v_cvt_pk_bf16_f32 v19, v86, v87
    buffer_store_dwordx4 v[16:19], v200, s[40:43], s6 offen offset:512 sc1
    v_cvt_pk_bf16_f32 v20, v88, v89
    v_cvt_pk_bf16_f32 v21, v90, v91
    v_cvt_pk_bf16_f32 v22, v92, v93
    v_cvt_pk_bf16_f32 v23, v94, v95
    buffer_store_dwordx4 v[20:23], v200, s[40:43], s6 offen offset:768 sc1
    s_mov_b64 exec, s[52:53]
    ds_write_b128 v201, v[8:11] offset:1024
    ds_write_b128 v201, v[12:15] offset:1280
    ds_write_b128 v201, v[16:19] offset:1536
    ds_write_b128 v201, v[20:23] offset:1792
    s_mov_b64 exec, -1
Lred:
    s_setprio 1
    s_lshl3_add_u32 s44, s47, s46
    s_lshl_b32 s6, s44, 10
    s_lshl_b32 s7, s45, 7
    s_add_u32 s6, s6, s7
    s_add_u32 s98, s6, 0x4a0000
    s_add_u32 s99, s6, s7
    s_load_dwordx2 s[32:33], s[0:1], 56
    s_mul_i32 s6, s45, 10240
    s_add_u32 s6, s6, 106496
    v_add_u32 v6, s6, v30
    ds_read_b128 v[120:123], v6 offset:0
    ds_read_b128 v[152:155], v6 offset:1024
    s_lshl_b32 s6, s45, 10
    v_add_u32 v81, s6, v30
    v_add_u32 v82, 4096, v81
    s_lshl_b32 s6, s44, 16
    s_add_u32 s38, s6, 0x800000
    s_mov_b32 s6, s46
    s_add_u32 s6, s6, 1
    s_cmp_ge_u32 s6, 7
    s_cselect_b32 s7, 7, 0
    s_sub_u32 s6, s6, s7
    s_lshl_b32 s7, s6, 13
    s_add_u32 s28, s7, s38
    s_add_u32 s6, s6, 1
    s_cmp_ge_u32 s6, 7
    s_cselect_b32 s7, 7, 0
    s_sub_u32 s6, s6, s7
    s_lshl_b32 s7, s6, 13
    s_add_u32 s29, s7, s38
    s_add_u32 s6, s6, 1
    s_cmp_ge_u32 s6, 7
    s_cselect_b32 s7, 7, 0
    s_sub_u32 s6, s6, s7
    s_lshl_b32 s7, s6, 13
    s_add_u32 s30, s7, s38
    s_add_u32 s6, s6, 1
    s_cmp_ge_u32 s6, 7
    s_cselect_b32 s7, 7, 0
    s_sub_u32 s6, s6, s7
    s_lshl_b32 s7, s6, 13
    s_add_u32 s31, s7, s38
    s_add_u32 s6, s6, 1
    s_cmp_ge_u32 s6, 7
    s_cselect_b32 s7, 7, 0
    s_sub_u32 s6, s6, s7
    s_lshl_b32 s7, s6, 13
    s_add_u32 s36, s7, s38
    s_add_u32 s6, s6, 1
    s_cmp_ge_u32 s6, 7
    s_cselect_b32 s7, 7, 0
    s_sub_u32 s6, s6, s7
    s_lshl_b32 s7, s6, 13
    s_add_u32 s37, s7, s38
    s_mov_b32 s34, 0x200000
    s_mov_b32 s35, 0x20000
    s_movk_i32 s6, 528
    v_lshrrev_b32 v4, 5, v1
    v_lshl_add_u32 v4, s45, 2, v4
    v_mul_lo_u32 v4, v4, s6
    v_and_b32 v5, 31, v0
    v_lshl_add_u32 v4, v5, 4, v4
    v_add_u32 v83, 149504, v4
    s_lshl_b32 s6, s45, 11
    s_add_u32 s6, s6, 139264
    v_and_b32 v4, 7, v1
    v_lshrrev_b32 v5, 3, v1
    v_mul_u32_u24 v6, 144, v4
    v_lshl_add_u32 v6, v5, 4, v6
    v_add_u32 v84, s6, v6
    v_mul_u32_u24 v6, 144, v5
    v_lshl_add_u32 v6, v4, 4, v6
    v_add_u32 v85, s6, v6
    v_lshlrev_b32 v6, 18, v5
    v_lshl_add_u32 v86, v4, 4, v6
    v_lshlrev_b32 v5, 2, v4
    v_add_u32 v87, 163136, v5
    s_waitcnt vmcnt(0)
    s_waitcnt lgkmcnt(0)
    s_cmp_eq_u32 s46, 7
    s_cbranch_scc1 Lnf1
    s_mov_b64 exec, 0xff
    buffer_store_dwordx2 v[24:25], v202, s[40:43], s96 offen offset:512 sc1
    s_mov_b64 exec, -1
    s_branch Lnf2
Lnf1:
    s_mov_b32 s92, 0x1000000
L53:
    s_sleep 4
    ds_read_b32 v28, v27 offset:0
    s_sub_u32 s92, s92, 1
    s_cbranch_scc1 L54
    s_waitcnt lgkmcnt(0)
    v_cmp_gt_u32 vcc, 4, v28
    s_cbranch_vccnz L53
L54:
Lnf2:
    s_mov_b32 s92, 400000
L55:
    s_load_dwordx16 s[8:23], s[40:41], s98 glc
    s_waitcnt lgkmcnt(0)
    s_xor_b64 s[8:9], s[8:9], s[48:49]
    s_xor_b64 s[10:11], s[10:11], s[48:49]
    s_or_b64 s[8:9], s[8:9], s[10:11]
    s_xor_b64 s[12:13], s[12:13], s[48:49]
    s_or_b64 s[8:9], s[8:9], s[12:13]
    s_xor_b64 s[14:15], s[14:15], s[48:49]
    s_or_b64 s[8:9], s[8:9], s[14:15]
    s_xor_b64 s[16:17], s[16:17], s[48:49]
    s_or_b64 s[8:9], s[8:9], s[16:17]
    s_xor_b64 s[18:19], s[18:19], s[48:49]
    s_or_b64 s[8:9], s[8:9], s[18:19]
    s_xor_b64 s[20:21], s[20:21], s[48:49]
    s_or_b64 s[8:9], s[8:9], s[20:21]
    s_cbranch_scc0 L56
    s_sleep 1
    s_sub_u32 s92, s92, 1
    s_cbranch_scc0 L55
L56:
    s_add_u32 s98, s98, 512
    s_load_dwordx16 s[8:23], s[40:41], s98 glc
    buffer_load_dwordx4 v[96:99], v81, s[40:43], s28 offen sc1
    buffer_load_dwordx4 v[100:103], v81, s[40:43], s29 offen sc1
    buffer_load_dwordx4 v[104:107], v81, s[40:43], s30 offen sc1
    buffer_load_dwordx4 v[108:111], v81, s[40:43], s31 offen sc1
    buffer_load_dwordx4 v[112:115], v81, s[40:43], s36 offen sc1
    buffer_load_dwordx4 v[116:119], v81, s[40:43], s37 offen sc1
    s_cmp_eq_u32 s46, 7
    s_cselect_b64 exec, -1, 0
    buffer_load_dwordx4 v[120:123], v81, s[40:43], s38 offen sc1
    s_mov_b64 exec, -1
    s_waitcnt lgkmcnt(0)
    s_xor_b64 s[8:9], s[8:9], s[48:49]
    s_xor_b64 s[10:11], s[10:11], s[48:49]
    s_or_b64 s[8:9], s[8:9], s[10:11]
    s_xor_b64 s[12:13], s[12:13], s[48:49]
    s_or_b64 s[8:9], s[8:9], s[12:13]
    s_xor_b64 s[14:15], s[14:15], s[48:49]
    s_or_b64 s[8:9], s[8:9], s[14:15]
    s_xor_b64 s[16:17], s[16:17], s[48:49]
    s_or_b64 s[8:9], s[8:9], s[16:17]
    s_xor_b64 s[18:19], s[18:19], s[48:49]
    s_or_b64 s[8:9], s[8:9], s[18:19]
    s_xor_b64 s[20:21], s[20:21], s[48:49]
    s_or_b64 s[8:9], s[8:9], s[20:21]
    s_cbranch_scc0 Lp1
    s_mov_b32 s92, 400000
L57:
    s_load_dwordx16 s[8:23], s[40:41], s98 glc
    s_waitcnt lgkmcnt(0)
    s_xor_b64 s[8:9], s[8:9], s[48:49]
    s_xor_b64 s[10:11], s[10:11], s[48:49]
    s_or_b64 s[8:9], s[8:9], s[10:11]
    s_xor_b64 s[12:13], s[12:13], s[48:49]
    s_or_b64 s[8:9], s[8:9], s[12:13]
    s_xor_b64 s[14:15], s[14:15], s[48:49]
    s_or_b64 s[8:9], s[8:9], s[14:15]
    s_xor_b64 s[16:17], s[16:17], s[48:49]
    s_or_b64 s[8:9], s[8:9], s[16:17]
    s_xor_b64 s[18:19], s[18:19], s[48:49]
    s_or_b64 s[8:9], s[8:9], s[18:19]
    s_xor_b64 s[20:21], s[20:21], s[48:49]
    s_or_b64 s[8:9], s[8:9], s[20:21]
    s_cbranch_scc0 L58
    s_sleep 1
    s_sub_u32 s92, s92, 1
    s_cbranch_scc0 L57
L58:
Lp1:
    buffer_load_dwordx4 v[128:131], v82, s[40:43], s28 offen sc1
    buffer_load_dwordx4 v[132:135], v82, s[40:43], s29 offen sc1
    buffer_load_dwordx4 v[136:139], v82, s[40:43], s30 offen sc1
    buffer_load_dwordx4 v[140:143], v82, s[40:43], s31 offen sc1
    buffer_load_dwordx4 v[144:147], v82, s[40:43], s36 offen sc1
    buffer_load_dwordx4 v[148:151], v82, s[40:43], s37 offen sc1
    s_cmp_eq_u32 s46, 7
    s_cselect_b64 exec, -1, 0
    buffer_load_dwordx4 v[152:155], v82, s[40:43], s38 offen sc1
    s_mov_b64 exec, -1
    s_waitcnt vmcnt(13)
    v_lshlrev_b32 v32, 16, v96
    v_and_b32 v33, 0xffff0000, v96
    v_lshlrev_b32 v34, 16, v97
    v_and_b32 v35, 0xffff0000, v97
    v_lshlrev_b32 v36, 16, v98
    v_and_b32 v37, 0xffff0000, v98
    v_lshlrev_b32 v38, 16, v99
    v_and_b32 v39, 0xffff0000, v99
    s_waitcnt vmcnt(12)
    v_lshlrev_b32 v56, 16, v100
    v_and_b32 v57, 0xffff0000, v100
    v_lshlrev_b32 v58, 16, v101
    v_and_b32 v59, 0xffff0000, v101
    v_lshlrev_b32 v60, 16, v102
    v_and_b32 v61, 0xffff0000, v102
    v_lshlrev_b32 v62, 16, v103
    v_and_b32 v63, 0xffff0000, v103
    v_pk_add_f32 v[32:33], v[32:33], v[56:57]
    v_pk_add_f32 v[34:35], v[34:35], v[58:59]
    v_pk_add_f32 v[36:37], v[36:37], v[60:61]
    v_pk_add_f32 v[38:39], v[38:39], v[62:63]
    s_waitcnt vmcnt(11)
    v_lshlrev_b32 v48, 16, v104
    v_and_b32 v49, 0xffff0000, v104
    v_lshlrev_b32 v50, 16, v105
    v_and_b32 v51, 0xffff0000, v105
    v_lshlrev_b32 v52, 16, v106
    v_and_b32 v53, 0xffff0000, v106
    v_lshlrev_b32 v54, 16, v107
    v_and_b32 v55, 0xffff0000, v107
    v_pk_add_f32 v[32:33], v[32:33], v[48:49]
    v_pk_add_f32 v[34:35], v[34:35], v[50:51]
    v_pk_add_f32 v[36:37], v[36:37], v[52:53]
    v_pk_add_f32 v[38:39], v[38:39], v[54:55]
    s_waitcnt vmcnt(10)
    v_lshlrev_b32 v56, 16, v108
    v_and_b32 v57, 0xffff0000, v108
    v_lshlrev_b32 v58, 16, v109
    v_and_b32 v59, 0xffff0000, v109
    v_lshlrev_b32 v60, 16, v110
    v_and_b32 v61, 0xffff0000, v110
    v_lshlrev_b32 v62, 16, v111
    v_and_b32 v63, 0xffff0000, v111
    v_pk_add_f32 v[32:33], v[32:33], v[56:57]
    v_pk_add_f32 v[34:35], v[34:35], v[58:59]
    v_pk_add_f32 v[36:37], v[36:37], v[60:61]
    v_pk_add_f32 v[38:39], v[38:39], v[62:63]
    s_waitcnt vmcnt(9)
    v_lshlrev_b32 v48, 16, v112
    v_and_b32 v49, 0xffff0000, v112
    v_lshlrev_b32 v50, 16, v113
    v_and_b32 v51, 0xffff0000, v113
    v_lshlrev_b32 v52, 16, v114
    v_and_b32 v53, 0xffff0000, v114
    v_lshlrev_b32 v54, 16, v115
    v_and_b32 v55, 0xffff0000, v115
    v_pk_add_f32 v[32:33], v[32:33], v[48:49]
    v_pk_add_f32 v[34:35], v[34:35], v[50:51]
    v_pk_add_f32 v[36:37], v[36:37], v[52:53]
    v_pk_add_f32 v[38:39], v[38:39], v[54:55]
    s_waitcnt vmcnt(8)
    v_lshlrev_b32 v56, 16, v116
    v_and_b32 v57, 0xffff0000, v116
    v_lshlrev_b32 v58, 16, v117
    v_and_b32 v59, 0xffff0000, v117
    v_lshlrev_b32 v60, 16, v118
    v_and_b32 v61, 0xffff0000, v118
    v_lshlrev_b32 v62, 16, v119
    v_and_b32 v63, 0xffff0000, v119
    v_pk_add_f32 v[32:33], v[32:33], v[56:57]
    v_pk_add_f32 v[34:35], v[34:35], v[58:59]
    v_pk_add_f32 v[36:37], v[36:37], v[60:61]
    v_pk_add_f32 v[38:39], v[38:39], v[62:63]
    s_waitcnt vmcnt(7)
    v_lshlrev_b32 v48, 16, v120
    v_and_b32 v49, 0xffff0000, v120
    v_lshlrev_b32 v50, 16, v121
    v_and_b32 v51, 0xffff0000, v121
    v_lshlrev_b32 v52, 16, v122
    v_and_b32 v53, 0xffff0000, v122
    v_lshlrev_b32 v54, 16, v123
    v_and_b32 v55, 0xffff0000, v123
    v_pk_add_f32 v[32:33], v[32:33], v[48:49]
    v_pk_add_f32 v[34:35], v[34:35], v[50:51]
    v_pk_add_f32 v[36:37], v[36:37], v[52:53]
    v_pk_add_f32 v[38:39], v[38:39], v[54:55]
    s_mov_b32 s92, 0x1000000
L59:
    s_sleep 1
    ds_read_b32 v28, v27 offset:0
    ds_read_b128 v[64:67], v83
    ds_read_b128 v[68:71], v83 offset:1056
    ds_read_b32 v80, v87
    s_sub_u32 s92, s92, 1
    s_cbranch_scc1 L60
    s_waitcnt lgkmcnt(3)
    v_cmp_gt_u32 vcc, 6, v28
    s_cbranch_vccnz L59
L60:
    s_setprio 3
    s_waitcnt lgkmcnt(2)
    v_lshlrev_b32 v48, 16, v64
    v_and_b32 v49, 0xffff0000, v64
    v_lshlrev_b32 v50, 16, v65
    v_and_b32 v51, 0xffff0000, v65
    v_lshlrev_b32 v52, 16, v66
    v_and_b32 v53, 0xffff0000, v66
    v_lshlrev_b32 v54, 16, v67
    v_and_b32 v55, 0xffff0000, v67
    s_waitcnt lgkmcnt(0)
    v_fma_f32 v32, v32, v80, v48
    v_fma_f32 v33, v33, v80, v49
    v_fma_f32 v34, v34, v80, v50
    v_fma_f32 v35, v35, v80, v51
    v_fma_f32 v36, v36, v80, v52
    v_fma_f32 v37, v37, v80, v53
    v_fma_f32 v38, v38, v80, v54
    v_fma_f32 v39, v39, v80, v55
    v_cvt_pk_bf16_f32 v64, v32, v33
    v_cvt_pk_bf16_f32 v65, v34, v35
    v_cvt_pk_bf16_f32 v66, v36, v37
    v_cvt_pk_bf16_f32 v67, v38, v39
    ds_write_b128 v84, v[64:67]
    ds_read_b128 v[72:75], v85
    v_lshlrev_b32 v32, 16, v68
    v_and_b32 v33, 0xffff0000, v68
    v_lshlrev_b32 v34, 16, v69
    v_and_b32 v35, 0xffff0000, v69
    v_lshlrev_b32 v36, 16, v70
    v_and_b32 v37, 0xffff0000, v70
    v_lshlrev_b32 v38, 16, v71
    v_and_b32 v39, 0xffff0000, v71
    s_waitcnt lgkmcnt(0)
    buffer_store_dwordx4 v[72:75], v86, s[32:35], s99 offen offset:0
    s_waitcnt vmcnt(7)
    v_lshlrev_b32 v40, 16, v128
    v_and_b32 v41, 0xffff0000, v128
    v_lshlrev_b32 v42, 16, v129
    v_and_b32 v43, 0xffff0000, v129
    v_lshlrev_b32 v44, 16, v130
    v_and_b32 v45, 0xffff0000, v130
    v_lshlrev_b32 v46, 16, v131
    v_and_b32 v47, 0xffff0000, v131
    s_waitcnt vmcnt(6)
    v_lshlrev_b32 v56, 16, v132
    v_and_b32 v57, 0xffff0000, v132
    v_lshlrev_b32 v58, 16, v133
    v_and_b32 v59, 0xffff0000, v133
    v_lshlrev_b32 v60, 16, v134
    v_and_b32 v61, 0xffff0000, v134
    v_lshlrev_b32 v62, 16, v135
    v_and_b32 v63, 0xffff0000, v135
    v_pk_add_f32 v[40:41], v[40:41], v[56:57]
    v_pk_add_f32 v[42:43], v[42:43], v[58:59]
    v_pk_add_f32 v[44:45], v[44:45], v[60:61]
    v_pk_add_f32 v[46:47], v[46:47], v[62:63]
    s_waitcnt vmcnt(5)
    v_lshlrev_b32 v48, 16, v136
    v_and_b32 v49, 0xffff0000, v136
    v_lshlrev_b32 v50, 16, v137
    v_and_b32 v51, 0xffff0000, v137
    v_lshlrev_b32 v52, 16, v138
    v_and_b32 v53, 0xffff0000, v138
    v_lshlrev_b32 v54, 16, v139
    v_and_b32 v55, 0xffff0000, v139
    v_pk_add_f32 v[40:41], v[40:41], v[48:49]
    v_pk_add_f32 v[42:43], v[42:43], v[50:51]
    v_pk_add_f32 v[44:45], v[44:45], v[52:53]
    v_pk_add_f32 v[46:47], v[46:47], v[54:55]
    s_waitcnt vmcnt(4)
    v_lshlrev_b32 v56, 16, v140
    v_and_b32 v57, 0xffff0000, v140
    v_lshlrev_b32 v58, 16, v141
    v_and_b32 v59, 0xffff0000, v141
    v_lshlrev_b32 v60, 16, v142
    v_and_b32 v61, 0xffff0000, v142
    v_lshlrev_b32 v62, 16, v143
    v_and_b32 v63, 0xffff0000, v143
    v_pk_add_f32 v[40:41], v[40:41], v[56:57]
    v_pk_add_f32 v[42:43], v[42:43], v[58:59]
    v_pk_add_f32 v[44:45], v[44:45], v[60:61]
    v_pk_add_f32 v[46:47], v[46:47], v[62:63]
    s_waitcnt vmcnt(3)
    v_lshlrev_b32 v48, 16, v144
    v_and_b32 v49, 0xffff0000, v144
    v_lshlrev_b32 v50, 16, v145
    v_and_b32 v51, 0xffff0000, v145
    v_lshlrev_b32 v52, 16, v146
    v_and_b32 v53, 0xffff0000, v146
    v_lshlrev_b32 v54, 16, v147
    v_and_b32 v55, 0xffff0000, v147
    v_pk_add_f32 v[40:41], v[40:41], v[48:49]
    v_pk_add_f32 v[42:43], v[42:43], v[50:51]
    v_pk_add_f32 v[44:45], v[44:45], v[52:53]
    v_pk_add_f32 v[46:47], v[46:47], v[54:55]
    s_waitcnt vmcnt(2)
    v_lshlrev_b32 v56, 16, v148
    v_and_b32 v57, 0xffff0000, v148
    v_lshlrev_b32 v58, 16, v149
    v_and_b32 v59, 0xffff0000, v149
    v_lshlrev_b32 v60, 16, v150
    v_and_b32 v61, 0xffff0000, v150
    v_lshlrev_b32 v62, 16, v151
    v_and_b32 v63, 0xffff0000, v151
    v_pk_add_f32 v[40:41], v[40:41], v[56:57]
    v_pk_add_f32 v[42:43], v[42:43], v[58:59]
    v_pk_add_f32 v[44:45], v[44:45], v[60:61]
    v_pk_add_f32 v[46:47], v[46:47], v[62:63]
    s_waitcnt vmcnt(1)
    v_lshlrev_b32 v48, 16, v152
    v_and_b32 v49, 0xffff0000, v152
    v_lshlrev_b32 v50, 16, v153
    v_and_b32 v51, 0xffff0000, v153
    v_lshlrev_b32 v52, 16, v154
    v_and_b32 v53, 0xffff0000, v154
    v_lshlrev_b32 v54, 16, v155
    v_and_b32 v55, 0xffff0000, v155
    v_pk_add_f32 v[40:41], v[40:41], v[48:49]
    v_pk_add_f32 v[42:43], v[42:43], v[50:51]
    v_pk_add_f32 v[44:45], v[44:45], v[52:53]
    v_pk_add_f32 v[46:47], v[46:47], v[54:55]
    v_fma_f32 v40, v40, v80, v32
    v_fma_f32 v41, v41, v80, v33
    v_fma_f32 v42, v42, v80, v34
    v_fma_f32 v43, v43, v80, v35
    v_fma_f32 v44, v44, v80, v36
    v_fma_f32 v45, v45, v80, v37
    v_fma_f32 v46, v46, v80, v38
    v_fma_f32 v47, v47, v80, v39
    v_cvt_pk_bf16_f32 v68, v40, v41
    v_cvt_pk_bf16_f32 v69, v42, v43
    v_cvt_pk_bf16_f32 v70, v44, v45
    v_cvt_pk_bf16_f32 v71, v46, v47
    ds_write_b128 v84, v[68:71]
    ds_read_b128 v[76:79], v85
    s_waitcnt lgkmcnt(0)
    buffer_store_dwordx4 v[76:79], v86, s[32:35], s99 offen offset:128
    s_endpgm
Lexit:
    s_endpgm
.section .rodata,"a"
.p2align 6
.amdhsa_kernel gated_mix__spectral_gfnet__dense_activation_silu__prompt_kernel
  .amdhsa_next_free_vgpr 256
  .amdhsa_next_free_sgpr 102
  .amdhsa_accum_offset 256
  .amdhsa_group_segment_fixed_size 0
  .amdhsa_kernarg_size 80
  .amdhsa_user_sgpr_count 2
  .amdhsa_user_sgpr_kernarg_segment_ptr 1
  .amdhsa_system_sgpr_workgroup_id_x 1
.end_amdhsa_kernel
```
